```python
import torch

def _softmax(x, axis=-1):
    return torch.softmax(x, dim=axis)
def _gelu(x):
    return torch.nn.functional.gelu(x, approximate="tanh")
def _silu(x):
    return torch.nn.functional.silu(x)
def _sigmoid(x):
    return torch.sigmoid(x)
def _layernorm(x, axis=-1, eps=1e-5):
    m = x.mean(dim=axis, keepdim=True)
    v = x.var(dim=axis, keepdim=True, unbiased=False)
    return (x - m) / torch.sqrt(v + eps)
def _scatter_add(tgt, idx, src, axis=0):
    return tgt.clone().index_add_(axis, idx, src)
def _segment_sum(src, seg, n):
    out = torch.zeros((n,) + src.shape[1:], dtype=src.dtype)
    return out.index_add_(0, seg, src)
def _pad(x, pw):
    flat = tuple(v for pair in reversed(pw) for v in pair)
    return torch.nn.functional.pad(x, flat)

kernel_name = 'recurrent_scan__mha_block__dense_activation_squared_relu__prompt'

def setup_inputs():

    _w = (lambda a: (lambda t: t.to(torch.bfloat16) if t.is_floating_point() else t)(torch.as_tensor(a)))
    def _A_setup():
        B, S, D, H = 1, 2048, 512, 32
        return {
            "x": _w((lambda *s: torch.randn(*s, dtype=torch.bfloat16) * 0.05)(B, S, D)),
            "wqkv": _w((lambda *s: torch.randn(*s, dtype=torch.bfloat16) * 0.05)(D, 3 * D)),
            "wo": _w((lambda *s: torch.randn(*s, dtype=torch.bfloat16) * 0.05)(D, D)),
        }
    _A_in = _A_setup()

    def _B_setup():
        B, S, D, F = 1, 2048, 512, 1792
        return {
            "x": _w((lambda *s: torch.randn(*s, dtype=torch.bfloat16) * 0.05)(B, S, D)),
            "w1": _w((lambda *s: torch.randn(*s, dtype=torch.bfloat16) * 0.05)(D, F)),
            "b1": _w((lambda *s: torch.randn(*s, dtype=torch.bfloat16) * 0.4)(F)),
            "w2": _w((lambda *s: torch.randn(*s, dtype=torch.bfloat16) * 0.05)(F, D)),
            "b2": _w((lambda *s: torch.randn(*s, dtype=torch.bfloat16) * 1.6)(D)),
        }
    _B_in = _B_setup()

    return {
        "A_x": _A_in["x"],
        "A_wqkv": _A_in["wqkv"],
        "A_wo": _A_in["wo"],
        "B_x": _B_in["x"],
        "B_w1": _B_in["w1"],
        "B_b1": _B_in["b1"],
        "B_w2": _B_in["w2"],
        "B_b2": _B_in["b2"],
    }

def reference(A_x, A_wqkv, A_wo, B_x, B_w1, B_b1, B_w2, B_b2):
    def _A_ref(x, wqkv, wo):
        B, S, D = x.shape
        H = 32
        Dh = D // H
        qkv = (lambda x, *d: x.permute(*d))((x @ wqkv).reshape(B, S, 3, H, Dh), 2, 0, 3, 1, 4)
        q, k, v = qkv[0], qkv[1], qkv[2]
        scores = torch.einsum("bhqd,bhkd->bhqk", q, k) * (Dh ** -0.5)
        p = _softmax(scores, axis=-1)
        o = torch.einsum("bhqk,bhkd->bhqd", p, v)
        return (lambda x, *d: x.permute(*d))(o, 0, 2, 1, 3).reshape(B, S, D) @ wo

    def _B_ref(x, w1, b1, w2, b2):
        h = torch.einsum("bsd,df->bsf", x, w1) + b1
        zero = torch.zeros_like(h)
        r = torch.where(h > zero, h, zero)
        h = r * r
        out = torch.einsum("bsf,fd->bsd", h, w2) + b2
        return out

    x = A_x
    xn = _layernorm(x, axis=-1)
    s = _A_ref(xn, A_wqkv, A_wo)
    g = _silu(_B_ref(xn, B_w1, B_b1, B_w2, B_b2))
    return x + s * g
```

```asm
; @launch grid=(256,1,1) block=(768,1,1) lds=163840
.amdgcn_target "amdgcn-amd-amdhsa--gfx950"
.text
.globl recurrent_scan__mha_block__dense_activation_squared_relu__prompt_kernel
.p2align 8
.type recurrent_scan__mha_block__dense_activation_squared_relu__prompt_kernel,@function
recurrent_scan__mha_block__dense_activation_squared_relu__prompt_kernel:
  s_cmp_ge_u32 s2, 256
  s_cbranch_scc1 L_end
  s_load_dwordx16 s[4:19], s[0:1], 0
  s_load_dwordx4 s[20:23], s[0:1], 64
  s_load_dwordx2 s[24:25], s[0:1], 80
  v_lshrrev_b32 v1, 6, v0
  v_and_b32 v0, 63, v0
  s_and_b32 s26, s2, 1
  v_readfirstlane_b32 s3, v1
  s_lshl_b32 s26, s26, 3
  s_bfe_u32 s42, s2, 0x30003
  s_add_u32 s26, s26, s42
  s_bfe_u32 s27, s2, 0x20001
  s_lshl_b32 s27, s27, 2
  s_lshr_b32 s42, s2, 6
  s_add_u32 s27, s27, s42
  s_mov_b32 s41, 0x3f803f80
  s_cmp_lt_u32 s3, 3
  s_cbranch_scc1 L_role_qkv
  s_cmp_ge_u32 s3, 8
  s_cbranch_scc1 L_role_ffn
  s_cmp_eq_u32 s3, 3
  s_cbranch_scc1 L_role_w3
L_role_x:
  v_lshrrev_b32 v1, 3, v0
  v_lshrrev_b32 v2, 4, v0
  v_and_b32 v3, 7, v0
  v_xor_b32 v3, v2, v3
  v_lshlrev_b32 v3, 4, v3
  v_lshl_or_b32 v2, v1, 10, v3
  v_xor_b32 v3, 64, v2
  s_sub_u32 s42, s3, 4
  s_lshl_b32 s43, s26, 17
  s_lshl_b32 s44, s42, 15
  s_add_u32 s43, s43, s44
  s_lshl_b32 s44, s42, 12
  s_waitcnt lgkmcnt(0)
  s_mov_b32 s32, s4
  s_and_b32 s33, s5, 0xffff
  s_mov_b32 s34, 2097152
  s_mov_b32 s35, 0x20000
  s_add_u32 m0, s44, 0
  s_add_u32 s45, s43, 0
  buffer_load_dwordx4 v2, s[32:35], s45 offen lds
  s_add_u32 m0, s44, 1024
  s_add_u32 s45, s43, 8192
  buffer_load_dwordx4 v3, s[32:35], s45 offen lds
  s_add_u32 m0, s44, 2048
  s_add_u32 s45, s43, 16384
  buffer_load_dwordx4 v2, s[32:35], s45 offen lds
  s_add_u32 m0, s44, 3072
  s_add_u32 s45, s43, 24576
  buffer_load_dwordx4 v3, s[32:35], s45 offen lds
  s_add_u32 m0, s44, 16384
  s_add_u32 s45, s43, 128
  buffer_load_dwordx4 v2, s[32:35], s45 offen lds
  s_add_u32 m0, s44, 17408
  s_add_u32 s45, s43, 8320
  buffer_load_dwordx4 v3, s[32:35], s45 offen lds
  s_add_u32 m0, s44, 18432
  s_add_u32 s45, s43, 16512
  buffer_load_dwordx4 v2, s[32:35], s45 offen lds
  s_add_u32 m0, s44, 19456
  s_add_u32 s45, s43, 24704
  buffer_load_dwordx4 v3, s[32:35], s45 offen lds
  s_mov_b32 s28, s24
  s_and_b32 s29, s25, 0xffff
  s_mov_b32 s30, 17104896
  s_mov_b32 s31, 0x20000
  s_lshl_b32 s46, s42, 2
  s_add_u32 s46, s46, 161808
  v_mov_b32 v4, s46
  v_mov_b32 v5, 0
  ds_write_b32 v4, v5
  s_waitcnt lgkmcnt(0)
  s_barrier
  v_mov_b32 v5, 1
  s_waitcnt vmcnt(4)
  ds_write_b32 v4, v5
  s_add_u32 m0, s44, 32768
  s_add_u32 s45, s43, 256
  buffer_load_dwordx4 v2, s[32:35], s45 offen lds
  s_add_u32 m0, s44, 33792
  s_add_u32 s45, s43, 8448
  buffer_load_dwordx4 v3, s[32:35], s45 offen lds
  s_add_u32 m0, s44, 34816
  s_add_u32 s45, s43, 16640
  buffer_load_dwordx4 v2, s[32:35], s45 offen lds
  s_add_u32 m0, s44, 35840
  s_add_u32 s45, s43, 24832
  buffer_load_dwordx4 v3, s[32:35], s45 offen lds
  s_add_u32 m0, s44, 49152
  s_add_u32 s45, s43, 384
  buffer_load_dwordx4 v2, s[32:35], s45 offen lds
  s_add_u32 m0, s44, 50176
  s_add_u32 s45, s43, 8576
  buffer_load_dwordx4 v3, s[32:35], s45 offen lds
  s_add_u32 m0, s44, 51200
  s_add_u32 s45, s43, 16768
  buffer_load_dwordx4 v2, s[32:35], s45 offen lds
  s_add_u32 m0, s44, 52224
  s_add_u32 s45, s43, 24960
  buffer_load_dwordx4 v3, s[32:35], s45 offen lds
  v_mov_b32 v5, 2
  s_waitcnt vmcnt(8)
  ds_write_b32 v4, v5
  s_add_u32 m0, s44, 65536
  s_add_u32 s45, s43, 512
  buffer_load_dwordx4 v2, s[32:35], s45 offen lds
  s_add_u32 m0, s44, 66560
  s_add_u32 s45, s43, 8704
  buffer_load_dwordx4 v3, s[32:35], s45 offen lds
  s_add_u32 m0, s44, 67584
  s_add_u32 s45, s43, 16896
  buffer_load_dwordx4 v2, s[32:35], s45 offen lds
  s_add_u32 m0, s44, 68608
  s_add_u32 s45, s43, 25088
  buffer_load_dwordx4 v3, s[32:35], s45 offen lds
  s_add_u32 m0, s44, 81920
  s_add_u32 s45, s43, 640
  buffer_load_dwordx4 v2, s[32:35], s45 offen lds
  s_add_u32 m0, s44, 82944
  s_add_u32 s45, s43, 8832
  buffer_load_dwordx4 v3, s[32:35], s45 offen lds
  s_add_u32 m0, s44, 83968
  s_add_u32 s45, s43, 17024
  buffer_load_dwordx4 v2, s[32:35], s45 offen lds
  s_add_u32 m0, s44, 84992
  s_add_u32 s45, s43, 25216
  buffer_load_dwordx4 v3, s[32:35], s45 offen lds
  v_mov_b32 v5, 3
  s_waitcnt vmcnt(12)
  ds_write_b32 v4, v5
  s_add_u32 m0, s44, 98304
  s_add_u32 s45, s43, 768
  buffer_load_dwordx4 v2, s[32:35], s45 offen lds
  s_add_u32 m0, s44, 99328
  s_add_u32 s45, s43, 8960
  buffer_load_dwordx4 v3, s[32:35], s45 offen lds
  s_add_u32 m0, s44, 100352
  s_add_u32 s45, s43, 17152
  buffer_load_dwordx4 v2, s[32:35], s45 offen lds
  s_add_u32 m0, s44, 101376
  s_add_u32 s45, s43, 25344
  buffer_load_dwordx4 v3, s[32:35], s45 offen lds
  v_mov_b32 v5, 4
  s_waitcnt vmcnt(12)
  ds_write_b32 v4, v5
  s_add_u32 m0, s44, 114688
  s_add_u32 s45, s43, 896
  buffer_load_dwordx4 v2, s[32:35], s45 offen lds
  s_add_u32 m0, s44, 115712
  s_add_u32 s45, s43, 9088
  buffer_load_dwordx4 v3, s[32:35], s45 offen lds
  s_add_u32 m0, s44, 116736
  s_add_u32 s45, s43, 17280
  buffer_load_dwordx4 v2, s[32:35], s45 offen lds
  s_add_u32 m0, s44, 117760
  s_add_u32 s45, s43, 25472
  buffer_load_dwordx4 v3, s[32:35], s45 offen lds
  v_mov_b32 v5, 5
  s_waitcnt vmcnt(12)
  ds_write_b32 v4, v5
  v_mov_b32 v5, 6
  s_waitcnt vmcnt(8)
  ds_write_b32 v4, v5
  v_mov_b32 v5, 7
  s_waitcnt vmcnt(4)
  ds_write_b32 v4, v5
  v_mov_b32 v5, 8
  s_waitcnt vmcnt(0)
  ds_write_b32 v4, v5
  s_waitcnt lgkmcnt(0)
  s_barrier
  v_mov_b32 v40, 161792
  ds_read_b32 v40, v40
  s_waitcnt lgkmcnt(0)
  v_readfirstlane_b32 s40, v40
  s_barrier
  s_branch L_s2_idle
L_role_qkv:
  s_lshl_b32 s44, s3, 13
  s_add_u32 s44, s44, 131072
  s_mul_i32 s53, s27, 3
  s_add_u32 s53, s53, s3
  v_lshrrev_b32 v12, 2, v0
  s_mov_b32 s47, 3072
  v_mul_lo_u32 v12, v12, s47
  v_and_b32 v13, 3, v0
  v_lshl_add_u32 v9, v13, 4, v12
  s_lshl_b32 s42, s53, 6
  s_mov_b32 s43, 49152
  s_sub_u32 s42, s42, s43
  s_waitcnt lgkmcnt(0)
  s_mov_b32 s32, s6
  s_and_b32 s33, s7, 0xffff
  s_mov_b32 s34, 1572864
  s_mov_b32 s35, 0x20000
  s_add_u32 m0, s44, 0
  s_add_u32 s42, s42, s43
  buffer_load_dwordx4 v9, s[32:35], s42 offen lds
  s_add_u32 m0, s44, 1024
  s_add_u32 s42, s42, s43
  buffer_load_dwordx4 v9, s[32:35], s42 offen lds
  s_lshr_b32 s54, s53, 4
  s_and_b32 s55, s53, 15
  s_mov_b32 s28, s24
  s_and_b32 s29, s25, 0xffff
  s_mov_b32 s30, 17104896
  s_mov_b32 s31, 0x20000
  v_and_b32 v10, 31, v0
  v_lshrrev_b32 v11, 5, v0
  v_bfe_u32 v12, v0, 1, 3
  v_xor_b32 v12, v11, v12
  v_lshlrev_b32 v12, 4, v12
  v_lshl_or_b32 v4, v10, 7, v12
  v_xor_b32 v5, 32, v4
  v_xor_b32 v6, 64, v4
  v_xor_b32 v7, 96, v4
  v_bfe_u32 v12, v0, 2, 2
  v_lshl_add_u32 v12, v11, 3, v12
  v_lshlrev_b32 v12, 6, v12
  v_bfe_u32 v13, v0, 4, 1
  v_lshl_add_u32 v12, v13, 5, v12
  v_and_b32 v13, 3, v0
  v_lshl_add_u32 v8, v13, 3, v12
  v_add_u32 v8, s44, v8
  v_mov_b32 v64, 0
  v_mov_b32 v65, 0
  v_mov_b32 v66, 0
  v_mov_b32 v67, 0
  v_mov_b32 v68, 0
  v_mov_b32 v69, 0
  v_mov_b32 v70, 0
  v_mov_b32 v71, 0
  v_mov_b32 v72, 0
  v_mov_b32 v73, 0
  v_mov_b32 v74, 0
  v_mov_b32 v75, 0
  v_mov_b32 v76, 0
  v_mov_b32 v77, 0
  v_mov_b32 v78, 0
  v_mov_b32 v79, 0
  v_mov_b32 v80, 0
  v_mov_b32 v81, 0
  v_mov_b32 v82, 0
  v_mov_b32 v83, 0
  v_mov_b32 v84, 0
  v_mov_b32 v85, 0
  v_mov_b32 v86, 0
  v_mov_b32 v87, 0
  v_mov_b32 v88, 0
  v_mov_b32 v89, 0
  v_mov_b32 v90, 0
  v_mov_b32 v91, 0
  v_mov_b32 v92, 0
  v_mov_b32 v93, 0
  v_mov_b32 v94, 0
  v_mov_b32 v95, 0
  v_mov_b32 v96, 0
  v_mov_b32 v97, 0
  v_mov_b32 v98, 0
  v_mov_b32 v99, 0
  v_mov_b32 v100, 0
  v_mov_b32 v101, 0
  v_mov_b32 v102, 0
  v_mov_b32 v103, 0
  v_mov_b32 v104, 0
  v_mov_b32 v105, 0
  v_mov_b32 v106, 0
  v_mov_b32 v107, 0
  v_mov_b32 v108, 0
  v_mov_b32 v109, 0
  v_mov_b32 v110, 0
  v_mov_b32 v111, 0
  v_mov_b32 v112, 0
  v_mov_b32 v113, 0
  v_mov_b32 v114, 0
  v_mov_b32 v115, 0
  v_mov_b32 v116, 0
  v_mov_b32 v117, 0
  v_mov_b32 v118, 0
  v_mov_b32 v119, 0
  v_mov_b32 v120, 0
  v_mov_b32 v121, 0
  v_mov_b32 v122, 0
  v_mov_b32 v123, 0
  v_mov_b32 v124, 0
  v_mov_b32 v125, 0
  v_mov_b32 v126, 0
  v_mov_b32 v127, 0
  s_add_u32 m0, s44, 2048
  s_add_u32 s42, s42, s43
  buffer_load_dwordx4 v9, s[32:35], s42 offen lds
  s_add_u32 m0, s44, 3072
  s_add_u32 s42, s42, s43
  buffer_load_dwordx4 v9, s[32:35], s42 offen lds
  s_add_u32 m0, s44, 4096
  s_add_u32 s42, s42, s43
  buffer_load_dwordx4 v9, s[32:35], s42 offen lds
  s_add_u32 m0, s44, 5120
  s_add_u32 s42, s42, s43
  buffer_load_dwordx4 v9, s[32:35], s42 offen lds
  s_add_u32 m0, s44, 6144
  s_add_u32 s42, s42, s43
  buffer_load_dwordx4 v9, s[32:35], s42 offen lds
  s_add_u32 m0, s44, 7168
  s_add_u32 s42, s42, s43
  buffer_load_dwordx4 v9, s[32:35], s42 offen lds
  v_lshrrev_b32 v12, 4, v0
  v_xor_b32 v12, v12, v0
  v_and_b32 v12, 1, v12
  v_cmp_eq_u32 vcc, 0, v12
  v_mov_b32 v13, s41
  v_mov_b32 v56, 0
  v_mov_b32 v57, 0
  v_mov_b32 v58, 0
  v_mov_b32 v59, 0
  v_cndmask_b32 v60, 0, v13, vcc
  v_cndmask_b32 v61, 0, v13, vcc
  v_cndmask_b32 v62, 0, v13, vcc
  v_cndmask_b32 v63, 0, v13, vcc
  v_mov_b32 v148, 161808
  s_barrier
  s_mov_b32 s58, 0
L_wsp_1:
  ds_read_b128 v[144:147], v148
  s_add_u32 s58, s58, 1
  s_waitcnt lgkmcnt(0)
  v_min3_u32 v149, v144, v145, v146
  v_min_u32 v149, v149, v147
  s_nop 0
  v_readfirstlane_b32 s57, v149
  s_cmp_ge_u32 s58, 0x100000
  s_cbranch_scc1 L_wok_2
  s_cmp_lt_u32 s57, 1
  s_cbranch_scc1 L_wsp_1
L_wok_2:
  s_waitcnt vmcnt(7)
  ds_read_b64_tr_b16 v[48:49], v8 offset:0
  ds_read_b64_tr_b16 v[50:51], v8 offset:256
  ds_read_b128 v[16:19], v4 offset:0
  ds_read_b128 v[20:23], v4 offset:4096
  ds_read_b128 v[24:27], v4 offset:8192
  ds_read_b128 v[28:31], v4 offset:12288
  s_cmp_eq_u32 s54, 2
  s_cbranch_scc1 L_role_v
  s_mov_b32 s46, 0
  s_mov_b32 s45, s44
  s_mov_b32 s56, 1
L_gl_qk_3:
  s_cmp_eq_u32 s46, 3
  s_cselect_b32 s45, 196608, s45
  s_waitcnt lgkmcnt(0)
  v_mfma_f32_32x32x16_bf16 v[64:79], v[48:51], v[16:19], v[64:79]
  s_add_u32 m0, s45, 0
  s_add_u32 s42, s42, s43
  buffer_load_dwordx4 v9, s[32:35], s42 offen lds
  s_waitcnt vmcnt(7)
  ds_read_b64_tr_b16 v[52:53], v8 offset:1024
  ds_read_b64_tr_b16 v[54:55], v8 offset:1280
  v_mfma_f32_32x32x16_bf16 v[80:95], v[48:51], v[20:23], v[80:95]
  ds_read_b128 v[32:35], v5 offset:0
  ds_read_b128 v[36:39], v5 offset:4096
  ds_read_b128 v[40:43], v5 offset:8192
  ds_read_b128 v[44:47], v5 offset:12288
  v_mfma_f32_32x32x16_bf16 v[96:111], v[48:51], v[24:27], v[96:111]
  v_mfma_f32_16x16x32_bf16 v[56:59], v[48:51], v[60:63], v[56:59]
  v_mfma_f32_32x32x16_bf16 v[112:127], v[48:51], v[28:31], v[112:127]
  s_waitcnt lgkmcnt(0)
  v_mfma_f32_32x32x16_bf16 v[64:79], v[52:55], v[32:35], v[64:79]
  s_add_u32 m0, s45, 1024
  s_add_u32 s42, s42, s43
  buffer_load_dwordx4 v9, s[32:35], s42 offen lds
  s_waitcnt vmcnt(7)
  ds_read_b64_tr_b16 v[48:49], v8 offset:2048
  ds_read_b64_tr_b16 v[50:51], v8 offset:2304
  v_mfma_f32_32x32x16_bf16 v[80:95], v[52:55], v[36:39], v[80:95]
  ds_read_b128 v[16:19], v6 offset:0
  ds_read_b128 v[20:23], v6 offset:4096
  ds_read_b128 v[24:27], v6 offset:8192
  ds_read_b128 v[28:31], v6 offset:12288
  v_mfma_f32_32x32x16_bf16 v[96:111], v[52:55], v[40:43], v[96:111]
  v_mfma_f32_16x16x32_bf16 v[56:59], v[52:55], v[60:63], v[56:59]
  v_mfma_f32_32x32x16_bf16 v[112:127], v[52:55], v[44:47], v[112:127]
  s_waitcnt lgkmcnt(0)
  v_mfma_f32_32x32x16_bf16 v[64:79], v[48:51], v[16:19], v[64:79]
  s_add_u32 m0, s45, 2048
  s_add_u32 s42, s42, s43
  buffer_load_dwordx4 v9, s[32:35], s42 offen lds
  s_waitcnt vmcnt(7)
  ds_read_b64_tr_b16 v[52:53], v8 offset:3072
  ds_read_b64_tr_b16 v[54:55], v8 offset:3328
  v_mfma_f32_32x32x16_bf16 v[80:95], v[48:51], v[20:23], v[80:95]
  ds_read_b128 v[32:35], v7 offset:0
  ds_read_b128 v[36:39], v7 offset:4096
  ds_read_b128 v[40:43], v7 offset:8192
  ds_read_b128 v[44:47], v7 offset:12288
  ds_read_b128 v[144:147], v148
  v_mfma_f32_32x32x16_bf16 v[96:111], v[48:51], v[24:27], v[96:111]
  v_mfma_f32_16x16x32_bf16 v[56:59], v[48:51], v[60:63], v[56:59]
  v_mfma_f32_32x32x16_bf16 v[112:127], v[48:51], v[28:31], v[112:127]
  s_waitcnt lgkmcnt(0)
  v_mfma_f32_32x32x16_bf16 v[64:79], v[52:55], v[32:35], v[64:79]
  v_min3_u32 v149, v144, v145, v146
  s_add_u32 s56, s56, 1
  v_min_u32 v149, v149, v147
  s_min_u32 s56, s56, 8
  s_add_u32 m0, s45, 3072
  s_add_u32 s42, s42, s43
  buffer_load_dwordx4 v9, s[32:35], s42 offen lds
  v_readfirstlane_b32 s57, v149
  s_waitcnt vmcnt(7)
  ds_read_b64_tr_b16 v[48:49], v8 offset:4096
  ds_read_b64_tr_b16 v[50:51], v8 offset:4352
  s_cmp_ge_u32 s57, s56
  s_cbranch_scc1 L_xok_4
  s_mov_b32 s58, 0
L_xsp_5:
  ds_read_b128 v[144:147], v148
  s_add_u32 s58, s58, 1
  s_waitcnt lgkmcnt(0)
  v_min3_u32 v149, v144, v145, v146
  v_min_u32 v149, v149, v147
  s_nop 0
  v_readfirstlane_b32 s57, v149
  s_cmp_ge_u32 s58, 0x100000
  s_cbranch_scc1 L_xok_4
  s_cmp_lt_u32 s57, s56
  s_cbranch_scc1 L_xsp_5
L_xok_4:
  v_mfma_f32_32x32x16_bf16 v[80:95], v[52:55], v[36:39], v[80:95]
  ds_read_b128 v[16:19], v4 offset:16384
  ds_read_b128 v[20:23], v4 offset:20480
  ds_read_b128 v[24:27], v4 offset:24576
  ds_read_b128 v[28:31], v4 offset:28672
  v_mfma_f32_32x32x16_bf16 v[96:111], v[52:55], v[40:43], v[96:111]
  v_mfma_f32_16x16x32_bf16 v[56:59], v[52:55], v[60:63], v[56:59]
  v_mfma_f32_32x32x16_bf16 v[112:127], v[52:55], v[44:47], v[112:127]
  s_waitcnt lgkmcnt(0)
  v_mfma_f32_32x32x16_bf16 v[64:79], v[48:51], v[16:19], v[64:79]
  s_add_u32 m0, s45, 4096
  s_add_u32 s42, s42, s43
  buffer_load_dwordx4 v9, s[32:35], s42 offen lds
  s_waitcnt vmcnt(7)
  ds_read_b64_tr_b16 v[52:53], v8 offset:5120
  ds_read_b64_tr_b16 v[54:55], v8 offset:5376
  v_mfma_f32_32x32x16_bf16 v[80:95], v[48:51], v[20:23], v[80:95]
  ds_read_b128 v[32:35], v5 offset:16384
  ds_read_b128 v[36:39], v5 offset:20480
  ds_read_b128 v[40:43], v5 offset:24576
  ds_read_b128 v[44:47], v5 offset:28672
  v_mfma_f32_32x32x16_bf16 v[96:111], v[48:51], v[24:27], v[96:111]
  v_mfma_f32_16x16x32_bf16 v[56:59], v[48:51], v[60:63], v[56:59]
  v_mfma_f32_32x32x16_bf16 v[112:127], v[48:51], v[28:31], v[112:127]
  s_waitcnt lgkmcnt(0)
  v_mfma_f32_32x32x16_bf16 v[64:79], v[52:55], v[32:35], v[64:79]
  s_add_u32 m0, s45, 5120
  s_add_u32 s42, s42, s43
  buffer_load_dwordx4 v9, s[32:35], s42 offen lds
  s_waitcnt vmcnt(7)
  ds_read_b64_tr_b16 v[48:49], v8 offset:6144
  ds_read_b64_tr_b16 v[50:51], v8 offset:6400
  v_mfma_f32_32x32x16_bf16 v[80:95], v[52:55], v[36:39], v[80:95]
  ds_read_b128 v[16:19], v6 offset:16384
  ds_read_b128 v[20:23], v6 offset:20480
  ds_read_b128 v[24:27], v6 offset:24576
  ds_read_b128 v[28:31], v6 offset:28672
  v_mfma_f32_32x32x16_bf16 v[96:111], v[52:55], v[40:43], v[96:111]
  v_mfma_f32_16x16x32_bf16 v[56:59], v[52:55], v[60:63], v[56:59]
  v_mfma_f32_32x32x16_bf16 v[112:127], v[52:55], v[44:47], v[112:127]
  s_waitcnt lgkmcnt(0)
  v_mfma_f32_32x32x16_bf16 v[64:79], v[48:51], v[16:19], v[64:79]
  s_add_u32 m0, s45, 6144
  s_add_u32 s42, s42, s43
  buffer_load_dwordx4 v9, s[32:35], s42 offen lds
  s_waitcnt vmcnt(7)
  ds_read_b64_tr_b16 v[52:53], v8 offset:7168
  ds_read_b64_tr_b16 v[54:55], v8 offset:7424
  v_mfma_f32_32x32x16_bf16 v[80:95], v[48:51], v[20:23], v[80:95]
  ds_read_b128 v[32:35], v7 offset:16384
  ds_read_b128 v[36:39], v7 offset:20480
  ds_read_b128 v[40:43], v7 offset:24576
  ds_read_b128 v[44:47], v7 offset:28672
  ds_read_b128 v[144:147], v148
  v_mfma_f32_32x32x16_bf16 v[96:111], v[48:51], v[24:27], v[96:111]
  v_mfma_f32_16x16x32_bf16 v[56:59], v[48:51], v[60:63], v[56:59]
  v_mfma_f32_32x32x16_bf16 v[112:127], v[48:51], v[28:31], v[112:127]
  s_waitcnt lgkmcnt(0)
  v_mfma_f32_32x32x16_bf16 v[64:79], v[52:55], v[32:35], v[64:79]
  v_min3_u32 v149, v144, v145, v146
  s_add_u32 s56, s56, 1
  v_min_u32 v149, v149, v147
  s_min_u32 s56, s56, 8
  s_add_u32 m0, s45, 7168
  s_add_u32 s42, s42, s43
  buffer_load_dwordx4 v9, s[32:35], s42 offen lds
  v_readfirstlane_b32 s57, v149
  s_waitcnt vmcnt(7)
  ds_read_b64_tr_b16 v[48:49], v8 offset:0
  ds_read_b64_tr_b16 v[50:51], v8 offset:256
  s_cmp_ge_u32 s57, s56
  s_cbranch_scc1 L_xok_6
  s_mov_b32 s58, 0
L_xsp_7:
  ds_read_b128 v[144:147], v148
  s_add_u32 s58, s58, 1
  s_waitcnt lgkmcnt(0)
  v_min3_u32 v149, v144, v145, v146
  v_min_u32 v149, v149, v147
  s_nop 0
  v_readfirstlane_b32 s57, v149
  s_cmp_ge_u32 s58, 0x100000
  s_cbranch_scc1 L_xok_6
  s_cmp_lt_u32 s57, s56
  s_cbranch_scc1 L_xsp_7
L_xok_6:
  v_mfma_f32_32x32x16_bf16 v[80:95], v[52:55], v[36:39], v[80:95]
  ds_read_b128 v[16:19], v4 offset:32768
  ds_read_b128 v[20:23], v4 offset:36864
  ds_read_b128 v[24:27], v4 offset:40960
  ds_read_b128 v[28:31], v4 offset:45056
  v_mfma_f32_32x32x16_bf16 v[96:111], v[52:55], v[40:43], v[96:111]
  v_mfma_f32_16x16x32_bf16 v[56:59], v[52:55], v[60:63], v[56:59]
  v_mfma_f32_32x32x16_bf16 v[112:127], v[52:55], v[44:47], v[112:127]
  v_add_u32 v4, 0x8000, v4
  v_add_u32 v5, 0x8000, v5
  v_add_u32 v6, 0x8000, v6
  v_add_u32 v7, 0x8000, v7
  s_add_u32 s46, s46, 1
  s_cmp_lt_u32 s46, 4
  s_cbranch_scc1 L_gl_qk_3
  s_barrier
  v_and_b32 v10, 31, v0
  v_lshlrev_b32 v10, 2, v10
  v_add_u32 v10, 162816, v10
  ds_read_b32 v32, v10 offset:0
  ds_read_b32 v33, v10 offset:512
  ds_read_b32 v34, v10 offset:128
  ds_read_b32 v35, v10 offset:640
  ds_read_b32 v36, v10 offset:256
  ds_read_b32 v37, v10 offset:768
  ds_read_b32 v38, v10 offset:384
  ds_read_b32 v39, v10 offset:896
  v_mov_b32 v40, 161792
  ds_read_b32 v40, v40
  s_nop 3
  v_lshrrev_b32 v11, 5, v0
  v_lshlrev_b32 v11, 6, v11
  s_waitcnt lgkmcnt(0)
  ds_bpermute_b32 v16, v11, v56 offset:0
  ds_bpermute_b32 v17, v11, v57 offset:0
  ds_bpermute_b32 v18, v11, v58 offset:0
  ds_bpermute_b32 v19, v11, v59 offset:0
  ds_bpermute_b32 v20, v11, v56 offset:128
  ds_bpermute_b32 v21, v11, v57 offset:128
  ds_bpermute_b32 v22, v11, v58 offset:128
  ds_bpermute_b32 v23, v11, v59 offset:128
  ds_bpermute_b32 v24, v11, v56 offset:4
  ds_bpermute_b32 v25, v11, v57 offset:4
  ds_bpermute_b32 v26, v11, v58 offset:4
  ds_bpermute_b32 v27, v11, v59 offset:4
  ds_bpermute_b32 v28, v11, v56 offset:132
  ds_bpermute_b32 v29, v11, v57 offset:132
  ds_bpermute_b32 v30, v11, v58 offset:132
  ds_bpermute_b32 v31, v11, v59 offset:132
  s_waitcnt lgkmcnt(0)
  v_readfirstlane_b32 s40, v40
  s_cmp_eq_u32 s54, 0
  s_cselect_b32 s47, 1052289595, 1.0
  v_mul_f32 v32, s47, v32
  v_mul_f32 v33, s47, v33
  v_mul_f32 v34, s47, v34
  v_mul_f32 v35, s47, v35
  v_mul_f32 v36, s47, v36
  v_mul_f32 v37, s47, v37
  v_mul_f32 v38, s47, v38
  v_mul_f32 v39, s47, v39
  s_lshl_b32 s48, s54, 21
  s_lshl_b32 s49, s55, 17
  s_add_u32 s48, s48, s49
  s_lshl_b32 s49, s26, 12
  s_add_u32 s48, s48, s49
  v_lshlrev_b32 v10, 4, v0
  v_mul_f32 v44, v16, v33
  v_mul_f32 v45, v17, v33
  v_fma_f32 v64, v64, v32, v44
  v_fma_f32 v65, v65, v32, v45
  v_cvt_pk_bf16_f32 v48, v64, v65
  v_mul_f32 v46, v18, v33
  v_mul_f32 v47, v19, v33
  v_fma_f32 v66, v66, v32, v46
  v_fma_f32 v67, v67, v32, v47
  v_cvt_pk_bf16_f32 v49, v66, v67
  v_mul_f32 v44, v20, v33
  v_mul_f32 v45, v21, v33
  v_fma_f32 v68, v68, v32, v44
  v_fma_f32 v69, v69, v32, v45
  v_cvt_pk_bf16_f32 v50, v68, v69
  v_mul_f32 v46, v22, v33
  v_mul_f32 v47, v23, v33
  v_fma_f32 v70, v70, v32, v46
  v_fma_f32 v71, v71, v32, v47
  v_cvt_pk_bf16_f32 v51, v70, v71
  s_add_u32 s49, s48, 0
  buffer_store_dwordx4 v[48:51], v10, s[28:31], s49 offen sc1
  v_mul_f32 v44, v24, v33
  v_mul_f32 v45, v25, v33
  v_fma_f32 v72, v72, v32, v44
  v_fma_f32 v73, v73, v32, v45
  v_cvt_pk_bf16_f32 v52, v72, v73
  v_mul_f32 v46, v26, v33
  v_mul_f32 v47, v27, v33
  v_fma_f32 v74, v74, v32, v46
  v_fma_f32 v75, v75, v32, v47
  v_cvt_pk_bf16_f32 v53, v74, v75
  v_mul_f32 v44, v28, v33
  v_mul_f32 v45, v29, v33
  v_fma_f32 v76, v76, v32, v44
  v_fma_f32 v77, v77, v32, v45
  v_cvt_pk_bf16_f32 v54, v76, v77
  v_mul_f32 v46, v30, v33
  v_mul_f32 v47, v31, v33
  v_fma_f32 v78, v78, v32, v46
  v_fma_f32 v79, v79, v32, v47
  v_cvt_pk_bf16_f32 v55, v78, v79
  s_add_u32 s49, s48, 65536
  buffer_store_dwordx4 v[52:55], v10, s[28:31], s49 offen sc1
  v_mul_f32 v44, v16, v35
  v_mul_f32 v45, v17, v35
  v_fma_f32 v80, v80, v34, v44
  v_fma_f32 v81, v81, v34, v45
  v_cvt_pk_bf16_f32 v48, v80, v81
  v_mul_f32 v46, v18, v35
  v_mul_f32 v47, v19, v35
  v_fma_f32 v82, v82, v34, v46
  v_fma_f32 v83, v83, v34, v47
  v_cvt_pk_bf16_f32 v49, v82, v83
  v_mul_f32 v44, v20, v35
  v_mul_f32 v45, v21, v35
  v_fma_f32 v84, v84, v34, v44
  v_fma_f32 v85, v85, v34, v45
  v_cvt_pk_bf16_f32 v50, v84, v85
  v_mul_f32 v46, v22, v35
  v_mul_f32 v47, v23, v35
  v_fma_f32 v86, v86, v34, v46
  v_fma_f32 v87, v87, v34, v47
  v_cvt_pk_bf16_f32 v51, v86, v87
  s_add_u32 s49, s48, 1024
  buffer_store_dwordx4 v[48:51], v10, s[28:31], s49 offen sc1
  v_mul_f32 v44, v24, v35
  v_mul_f32 v45, v25, v35
  v_fma_f32 v88, v88, v34, v44
  v_fma_f32 v89, v89, v34, v45
  v_cvt_pk_bf16_f32 v52, v88, v89
  v_mul_f32 v46, v26, v35
  v_mul_f32 v47, v27, v35
  v_fma_f32 v90, v90, v34, v46
  v_fma_f32 v91, v91, v34, v47
  v_cvt_pk_bf16_f32 v53, v90, v91
  v_mul_f32 v44, v28, v35
  v_mul_f32 v45, v29, v35
  v_fma_f32 v92, v92, v34, v44
  v_fma_f32 v93, v93, v34, v45
  v_cvt_pk_bf16_f32 v54, v92, v93
  v_mul_f32 v46, v30, v35
  v_mul_f32 v47, v31, v35
  v_fma_f32 v94, v94, v34, v46
  v_fma_f32 v95, v95, v34, v47
  v_cvt_pk_bf16_f32 v55, v94, v95
  s_add_u32 s49, s48, 66560
  buffer_store_dwordx4 v[52:55], v10, s[28:31], s49 offen sc1
  v_mul_f32 v44, v16, v37
  v_mul_f32 v45, v17, v37
  v_fma_f32 v96, v96, v36, v44
  v_fma_f32 v97, v97, v36, v45
  v_cvt_pk_bf16_f32 v48, v96, v97
  v_mul_f32 v46, v18, v37
  v_mul_f32 v47, v19, v37
  v_fma_f32 v98, v98, v36, v46
  v_fma_f32 v99, v99, v36, v47
  v_cvt_pk_bf16_f32 v49, v98, v99
  v_mul_f32 v44, v20, v37
  v_mul_f32 v45, v21, v37
  v_fma_f32 v100, v100, v36, v44
  v_fma_f32 v101, v101, v36, v45
  v_cvt_pk_bf16_f32 v50, v100, v101
  v_mul_f32 v46, v22, v37
  v_mul_f32 v47, v23, v37
  v_fma_f32 v102, v102, v36, v46
  v_fma_f32 v103, v103, v36, v47
  v_cvt_pk_bf16_f32 v51, v102, v103
  s_add_u32 s49, s48, 2048
  buffer_store_dwordx4 v[48:51], v10, s[28:31], s49 offen sc1
  v_mul_f32 v44, v24, v37
  v_mul_f32 v45, v25, v37
  v_fma_f32 v104, v104, v36, v44
  v_fma_f32 v105, v105, v36, v45
  v_cvt_pk_bf16_f32 v52, v104, v105
  v_mul_f32 v46, v26, v37
  v_mul_f32 v47, v27, v37
  v_fma_f32 v106, v106, v36, v46
  v_fma_f32 v107, v107, v36, v47
  v_cvt_pk_bf16_f32 v53, v106, v107
  v_mul_f32 v44, v28, v37
  v_mul_f32 v45, v29, v37
  v_fma_f32 v108, v108, v36, v44
  v_fma_f32 v109, v109, v36, v45
  v_cvt_pk_bf16_f32 v54, v108, v109
  v_mul_f32 v46, v30, v37
  v_mul_f32 v47, v31, v37
  v_fma_f32 v110, v110, v36, v46
  v_fma_f32 v111, v111, v36, v47
  v_cvt_pk_bf16_f32 v55, v110, v111
  s_add_u32 s49, s48, 67584
  buffer_store_dwordx4 v[52:55], v10, s[28:31], s49 offen sc1
  v_mul_f32 v44, v16, v39
  v_mul_f32 v45, v17, v39
  v_fma_f32 v112, v112, v38, v44
  v_fma_f32 v113, v113, v38, v45
  v_cvt_pk_bf16_f32 v48, v112, v113
  v_mul_f32 v46, v18, v39
  v_mul_f32 v47, v19, v39
  v_fma_f32 v114, v114, v38, v46
  v_fma_f32 v115, v115, v38, v47
  v_cvt_pk_bf16_f32 v49, v114, v115
  v_mul_f32 v44, v20, v39
  v_mul_f32 v45, v21, v39
  v_fma_f32 v116, v116, v38, v44
  v_fma_f32 v117, v117, v38, v45
  v_cvt_pk_bf16_f32 v50, v116, v117
  v_mul_f32 v46, v22, v39
  v_mul_f32 v47, v23, v39
  v_fma_f32 v118, v118, v38, v46
  v_fma_f32 v119, v119, v38, v47
  v_cvt_pk_bf16_f32 v51, v118, v119
  s_add_u32 s49, s48, 3072
  buffer_store_dwordx4 v[48:51], v10, s[28:31], s49 offen sc1
  v_mul_f32 v44, v24, v39
  v_mul_f32 v45, v25, v39
  v_fma_f32 v120, v120, v38, v44
  v_fma_f32 v121, v121, v38, v45
  v_cvt_pk_bf16_f32 v52, v120, v121
  v_mul_f32 v46, v26, v39
  v_mul_f32 v47, v27, v39
  v_fma_f32 v122, v122, v38, v46
  v_fma_f32 v123, v123, v38, v47
  v_cvt_pk_bf16_f32 v53, v122, v123
  v_mul_f32 v44, v28, v39
  v_mul_f32 v45, v29, v39
  v_fma_f32 v124, v124, v38, v44
  v_fma_f32 v125, v125, v38, v45
  v_cvt_pk_bf16_f32 v54, v124, v125
  v_mul_f32 v46, v30, v39
  v_mul_f32 v47, v31, v39
  v_fma_f32 v126, v126, v38, v46
  v_fma_f32 v127, v127, v38, v47
  v_cvt_pk_bf16_f32 v55, v126, v127
  s_add_u32 s49, s48, 68608
  buffer_store_dwordx4 v[52:55], v10, s[28:31], s49 offen sc1
  s_barrier
  s_lshl_b32 s48, s55, 8
  s_lshl_b32 s49, s54, 6
  s_add_u32 s48, s48, s49
  s_lshl_b32 s49, s26, 2
  s_add_u32 s48, s48, s49
  s_add_u32 s48, s48, 16777216
  s_waitcnt vmcnt(0)
  v_mov_b32 v12, s40
  v_mov_b32 v13, 0
  s_mov_b64 exec, 1
  buffer_store_dword v12, v13, s[28:31], s48 offen sc1
  s_mov_b64 exec, -1
  s_branch L_s2_idle
L_role_v:
  s_mov_b32 s46, 0
  s_mov_b32 s45, s44
  s_mov_b32 s56, 1
L_gl_v_8:
  s_cmp_eq_u32 s46, 3
  s_cselect_b32 s45, 196608, s45
  s_waitcnt lgkmcnt(0)
  v_mfma_f32_32x32x16_bf16 v[64:79], v[16:19], v[48:51], v[64:79]
  s_add_u32 m0, s45, 0
  s_add_u32 s42, s42, s43
  buffer_load_dwordx4 v9, s[32:35], s42 offen lds
  s_waitcnt vmcnt(7)
  ds_read_b64_tr_b16 v[52:53], v8 offset:1024
  ds_read_b64_tr_b16 v[54:55], v8 offset:1280
  v_mfma_f32_32x32x16_bf16 v[80:95], v[20:23], v[48:51], v[80:95]
  ds_read_b128 v[32:35], v5 offset:0
  ds_read_b128 v[36:39], v5 offset:4096
  ds_read_b128 v[40:43], v5 offset:8192
  ds_read_b128 v[44:47], v5 offset:12288
  v_mfma_f32_32x32x16_bf16 v[96:111], v[24:27], v[48:51], v[96:111]
  v_mfma_f32_16x16x32_bf16 v[56:59], v[48:51], v[60:63], v[56:59]
  v_mfma_f32_32x32x16_bf16 v[112:127], v[28:31], v[48:51], v[112:127]
  s_waitcnt lgkmcnt(0)
  v_mfma_f32_32x32x16_bf16 v[64:79], v[32:35], v[52:55], v[64:79]
  s_add_u32 m0, s45, 1024
  s_add_u32 s42, s42, s43
  buffer_load_dwordx4 v9, s[32:35], s42 offen lds
  s_waitcnt vmcnt(7)
  ds_read_b64_tr_b16 v[48:49], v8 offset:2048
  ds_read_b64_tr_b16 v[50:51], v8 offset:2304
  v_mfma_f32_32x32x16_bf16 v[80:95], v[36:39], v[52:55], v[80:95]
  ds_read_b128 v[16:19], v6 offset:0
  ds_read_b128 v[20:23], v6 offset:4096
  ds_read_b128 v[24:27], v6 offset:8192
  ds_read_b128 v[28:31], v6 offset:12288
  v_mfma_f32_32x32x16_bf16 v[96:111], v[40:43], v[52:55], v[96:111]
  v_mfma_f32_16x16x32_bf16 v[56:59], v[52:55], v[60:63], v[56:59]
  v_mfma_f32_32x32x16_bf16 v[112:127], v[44:47], v[52:55], v[112:127]
  s_waitcnt lgkmcnt(0)
  v_mfma_f32_32x32x16_bf16 v[64:79], v[16:19], v[48:51], v[64:79]
  s_add_u32 m0, s45, 2048
  s_add_u32 s42, s42, s43
  buffer_load_dwordx4 v9, s[32:35], s42 offen lds
  s_waitcnt vmcnt(7)
  ds_read_b64_tr_b16 v[52:53], v8 offset:3072
  ds_read_b64_tr_b16 v[54:55], v8 offset:3328
  v_mfma_f32_32x32x16_bf16 v[80:95], v[20:23], v[48:51], v[80:95]
  ds_read_b128 v[32:35], v7 offset:0
  ds_read_b128 v[36:39], v7 offset:4096
  ds_read_b128 v[40:43], v7 offset:8192
  ds_read_b128 v[44:47], v7 offset:12288
  ds_read_b128 v[144:147], v148
  v_mfma_f32_32x32x16_bf16 v[96:111], v[24:27], v[48:51], v[96:111]
  v_mfma_f32_16x16x32_bf16 v[56:59], v[48:51], v[60:63], v[56:59]
  v_mfma_f32_32x32x16_bf16 v[112:127], v[28:31], v[48:51], v[112:127]
  s_waitcnt lgkmcnt(0)
  v_mfma_f32_32x32x16_bf16 v[64:79], v[32:35], v[52:55], v[64:79]
  v_min3_u32 v149, v144, v145, v146
  s_add_u32 s56, s56, 1
  v_min_u32 v149, v149, v147
  s_min_u32 s56, s56, 8
  s_add_u32 m0, s45, 3072
  s_add_u32 s42, s42, s43
  buffer_load_dwordx4 v9, s[32:35], s42 offen lds
  v_readfirstlane_b32 s57, v149
  s_waitcnt vmcnt(7)
  ds_read_b64_tr_b16 v[48:49], v8 offset:4096
  ds_read_b64_tr_b16 v[50:51], v8 offset:4352
  s_cmp_ge_u32 s57, s56
  s_cbranch_scc1 L_xok_9
  s_mov_b32 s58, 0
L_xsp_10:
  ds_read_b128 v[144:147], v148
  s_add_u32 s58, s58, 1
  s_waitcnt lgkmcnt(0)
  v_min3_u32 v149, v144, v145, v146
  v_min_u32 v149, v149, v147
  s_nop 0
  v_readfirstlane_b32 s57, v149
  s_cmp_ge_u32 s58, 0x100000
  s_cbranch_scc1 L_xok_9
  s_cmp_lt_u32 s57, s56
  s_cbranch_scc1 L_xsp_10
L_xok_9:
  v_mfma_f32_32x32x16_bf16 v[80:95], v[36:39], v[52:55], v[80:95]
  ds_read_b128 v[16:19], v4 offset:16384
  ds_read_b128 v[20:23], v4 offset:20480
  ds_read_b128 v[24:27], v4 offset:24576
  ds_read_b128 v[28:31], v4 offset:28672
  v_mfma_f32_32x32x16_bf16 v[96:111], v[40:43], v[52:55], v[96:111]
  v_mfma_f32_16x16x32_bf16 v[56:59], v[52:55], v[60:63], v[56:59]
  v_mfma_f32_32x32x16_bf16 v[112:127], v[44:47], v[52:55], v[112:127]
  s_waitcnt lgkmcnt(0)
  v_mfma_f32_32x32x16_bf16 v[64:79], v[16:19], v[48:51], v[64:79]
  s_add_u32 m0, s45, 4096
  s_add_u32 s42, s42, s43
  buffer_load_dwordx4 v9, s[32:35], s42 offen lds
  s_waitcnt vmcnt(7)
  ds_read_b64_tr_b16 v[52:53], v8 offset:5120
  ds_read_b64_tr_b16 v[54:55], v8 offset:5376
  v_mfma_f32_32x32x16_bf16 v[80:95], v[20:23], v[48:51], v[80:95]
  ds_read_b128 v[32:35], v5 offset:16384
  ds_read_b128 v[36:39], v5 offset:20480
  ds_read_b128 v[40:43], v5 offset:24576
  ds_read_b128 v[44:47], v5 offset:28672
  v_mfma_f32_32x32x16_bf16 v[96:111], v[24:27], v[48:51], v[96:111]
  v_mfma_f32_16x16x32_bf16 v[56:59], v[48:51], v[60:63], v[56:59]
  v_mfma_f32_32x32x16_bf16 v[112:127], v[28:31], v[48:51], v[112:127]
  s_waitcnt lgkmcnt(0)
  v_mfma_f32_32x32x16_bf16 v[64:79], v[32:35], v[52:55], v[64:79]
  s_add_u32 m0, s45, 5120
  s_add_u32 s42, s42, s43
  buffer_load_dwordx4 v9, s[32:35], s42 offen lds
  s_waitcnt vmcnt(7)
  ds_read_b64_tr_b16 v[48:49], v8 offset:6144
  ds_read_b64_tr_b16 v[50:51], v8 offset:6400
  v_mfma_f32_32x32x16_bf16 v[80:95], v[36:39], v[52:55], v[80:95]
  ds_read_b128 v[16:19], v6 offset:16384
  ds_read_b128 v[20:23], v6 offset:20480
  ds_read_b128 v[24:27], v6 offset:24576
  ds_read_b128 v[28:31], v6 offset:28672
  v_mfma_f32_32x32x16_bf16 v[96:111], v[40:43], v[52:55], v[96:111]
  v_mfma_f32_16x16x32_bf16 v[56:59], v[52:55], v[60:63], v[56:59]
  v_mfma_f32_32x32x16_bf16 v[112:127], v[44:47], v[52:55], v[112:127]
  s_waitcnt lgkmcnt(0)
  v_mfma_f32_32x32x16_bf16 v[64:79], v[16:19], v[48:51], v[64:79]
  s_add_u32 m0, s45, 6144
  s_add_u32 s42, s42, s43
  buffer_load_dwordx4 v9, s[32:35], s42 offen lds
  s_waitcnt vmcnt(7)
  ds_read_b64_tr_b16 v[52:53], v8 offset:7168
  ds_read_b64_tr_b16 v[54:55], v8 offset:7424
  v_mfma_f32_32x32x16_bf16 v[80:95], v[20:23], v[48:51], v[80:95]
  ds_read_b128 v[32:35], v7 offset:16384
  ds_read_b128 v[36:39], v7 offset:20480
  ds_read_b128 v[40:43], v7 offset:24576
  ds_read_b128 v[44:47], v7 offset:28672
  ds_read_b128 v[144:147], v148
  v_mfma_f32_32x32x16_bf16 v[96:111], v[24:27], v[48:51], v[96:111]
  v_mfma_f32_16x16x32_bf16 v[56:59], v[48:51], v[60:63], v[56:59]
  v_mfma_f32_32x32x16_bf16 v[112:127], v[28:31], v[48:51], v[112:127]
  s_waitcnt lgkmcnt(0)
  v_mfma_f32_32x32x16_bf16 v[64:79], v[32:35], v[52:55], v[64:79]
  v_min3_u32 v149, v144, v145, v146
  s_add_u32 s56, s56, 1
  v_min_u32 v149, v149, v147
  s_min_u32 s56, s56, 8
  s_add_u32 m0, s45, 7168
  s_add_u32 s42, s42, s43
  buffer_load_dwordx4 v9, s[32:35], s42 offen lds
  v_readfirstlane_b32 s57, v149
  s_waitcnt vmcnt(7)
  ds_read_b64_tr_b16 v[48:49], v8 offset:0
  ds_read_b64_tr_b16 v[50:51], v8 offset:256
  s_cmp_ge_u32 s57, s56
  s_cbranch_scc1 L_xok_11
  s_mov_b32 s58, 0
L_xsp_12:
  ds_read_b128 v[144:147], v148
  s_add_u32 s58, s58, 1
  s_waitcnt lgkmcnt(0)
  v_min3_u32 v149, v144, v145, v146
  v_min_u32 v149, v149, v147
  s_nop 0
  v_readfirstlane_b32 s57, v149
  s_cmp_ge_u32 s58, 0x100000
  s_cbranch_scc1 L_xok_11
  s_cmp_lt_u32 s57, s56
  s_cbranch_scc1 L_xsp_12
L_xok_11:
  v_mfma_f32_32x32x16_bf16 v[80:95], v[36:39], v[52:55], v[80:95]
  ds_read_b128 v[16:19], v4 offset:32768
  ds_read_b128 v[20:23], v4 offset:36864
  ds_read_b128 v[24:27], v4 offset:40960
  ds_read_b128 v[28:31], v4 offset:45056
  v_mfma_f32_32x32x16_bf16 v[96:111], v[40:43], v[52:55], v[96:111]
  v_mfma_f32_16x16x32_bf16 v[56:59], v[52:55], v[60:63], v[56:59]
  v_mfma_f32_32x32x16_bf16 v[112:127], v[44:47], v[52:55], v[112:127]
  v_add_u32 v4, 0x8000, v4
  v_add_u32 v5, 0x8000, v5
  v_add_u32 v6, 0x8000, v6
  v_add_u32 v7, 0x8000, v7
  s_add_u32 s46, s46, 1
  s_cmp_lt_u32 s46, 4
  s_cbranch_scc1 L_gl_v_8
  s_barrier
  v_mov_b32 v40, 161792
  ds_read_b32 v40, v40
  v_bfe_u32 v12, v0, 2, 2
  v_bfe_u32 v13, v0, 4, 1
  v_lshl_add_u32 v12, v12, 4, v13
  v_lshlrev_b32 v12, 2, v12
  s_nop 3
  s_waitcnt lgkmcnt(0)
  ds_bpermute_b32 v16, v12, v56
  ds_bpermute_b32 v17, v12, v57
  ds_bpermute_b32 v18, v12, v58
  ds_bpermute_b32 v19, v12, v59
  v_and_b32 v13, 3, v0
  s_waitcnt lgkmcnt(0)
  v_cmp_eq_u32 vcc, 1, v13
  s_nop 1
  v_cndmask_b32 v16, v16, v17, vcc
  v_cmp_eq_u32 vcc, 2, v13
  s_nop 1
  v_cndmask_b32 v16, v16, v18, vcc
  v_cmp_eq_u32 vcc, 3, v13
  s_nop 1
  v_cndmask_b32 v16, v16, v19, vcc
  v_mov_b32 v56, v16
  v_lshrrev_b32 v11, 5, v0
  v_lshlrev_b32 v11, 4, v11
  v_add_u32 v11, 162816, v11
  v_bfe_u32 v12, v0, 4, 1
  v_lshlrev_b32 v12, 16, v12
  v_lshrrev_b32 v13, 5, v0
  v_lshl_add_u32 v12, v13, 8, v12
  v_and_b32 v13, 15, v0
  v_lshl_add_u32 v10, v13, 4, v12
  s_lshl_b32 s48, s55, 17
  s_lshl_b32 s49, s26, 12
  s_add_u32 s48, s48, s49
  s_add_u32 s48, s48, 4194304
  s_waitcnt lgkmcnt(0)
  v_readfirstlane_b32 s40, v40
  ds_read_b128 v[16:19], v11 offset:0
  ds_read_b128 v[32:35], v11 offset:512
  ds_read_b128 v[20:23], v11 offset:32
  ds_read_b128 v[36:39], v11 offset:544
  ds_read_b128 v[24:27], v11 offset:64
  ds_read_b128 v[40:43], v11 offset:576
  ds_read_b128 v[28:31], v11 offset:96
  ds_read_b128 v[44:47], v11 offset:608
  s_waitcnt lgkmcnt(0)
  v_mul_f32 v58, v32, v56
  v_mul_f32 v59, v33, v56
  v_fma_f32 v64, v64, v16, v58
  v_fma_f32 v65, v65, v17, v59
  v_cvt_pk_bf16_f32 v48, v64, v65
  v_mul_f32 v60, v34, v56
  v_mul_f32 v61, v35, v56
  v_fma_f32 v66, v66, v18, v60
  v_fma_f32 v67, v67, v19, v61
  v_cvt_pk_bf16_f32 v49, v66, v67
  v_mul_f32 v58, v36, v56
  v_mul_f32 v59, v37, v56
  v_fma_f32 v68, v68, v20, v58
  v_fma_f32 v69, v69, v21, v59
  v_cvt_pk_bf16_f32 v50, v68, v69
  v_mul_f32 v60, v38, v56
  v_mul_f32 v61, v39, v56
  v_fma_f32 v70, v70, v22, v60
  v_fma_f32 v71, v71, v23, v61
  v_cvt_pk_bf16_f32 v51, v70, v71
  s_add_u32 s49, s48, 0
  buffer_store_dwordx4 v[48:51], v10, s[28:31], s49 offen sc1
  v_mul_f32 v58, v40, v56
  v_mul_f32 v59, v41, v56
  v_fma_f32 v72, v72, v24, v58
  v_fma_f32 v73, v73, v25, v59
  v_cvt_pk_bf16_f32 v52, v72, v73
  v_mul_f32 v60, v42, v56
  v_mul_f32 v61, v43, v56
  v_fma_f32 v74, v74, v26, v60
  v_fma_f32 v75, v75, v27, v61
  v_cvt_pk_bf16_f32 v53, v74, v75
  v_mul_f32 v58, v44, v56
  v_mul_f32 v59, v45, v56
  v_fma_f32 v76, v76, v28, v58
  v_fma_f32 v77, v77, v29, v59
  v_cvt_pk_bf16_f32 v54, v76, v77
  v_mul_f32 v60, v46, v56
  v_mul_f32 v61, v47, v56
  v_fma_f32 v78, v78, v30, v60
  v_fma_f32 v79, v79, v31, v61
  v_cvt_pk_bf16_f32 v55, v78, v79
  s_add_u32 s49, s48, 512
  buffer_store_dwordx4 v[52:55], v10, s[28:31], s49 offen sc1
  ds_read_b128 v[16:19], v11 offset:128
  ds_read_b128 v[32:35], v11 offset:640
  ds_read_b128 v[20:23], v11 offset:160
  ds_read_b128 v[36:39], v11 offset:672
  ds_read_b128 v[24:27], v11 offset:192
  ds_read_b128 v[40:43], v11 offset:704
  ds_read_b128 v[28:31], v11 offset:224
  ds_read_b128 v[44:47], v11 offset:736
  s_waitcnt lgkmcnt(0)
  v_mul_f32 v58, v32, v56
  v_mul_f32 v59, v33, v56
  v_fma_f32 v80, v80, v16, v58
  v_fma_f32 v81, v81, v17, v59
  v_cvt_pk_bf16_f32 v48, v80, v81
  v_mul_f32 v60, v34, v56
  v_mul_f32 v61, v35, v56
  v_fma_f32 v82, v82, v18, v60
  v_fma_f32 v83, v83, v19, v61
  v_cvt_pk_bf16_f32 v49, v82, v83
  v_mul_f32 v58, v36, v56
  v_mul_f32 v59, v37, v56
  v_fma_f32 v84, v84, v20, v58
  v_fma_f32 v85, v85, v21, v59
  v_cvt_pk_bf16_f32 v50, v84, v85
  v_mul_f32 v60, v38, v56
  v_mul_f32 v61, v39, v56
  v_fma_f32 v86, v86, v22, v60
  v_fma_f32 v87, v87, v23, v61
  v_cvt_pk_bf16_f32 v51, v86, v87
  s_add_u32 s49, s48, 1024
  buffer_store_dwordx4 v[48:51], v10, s[28:31], s49 offen sc1
  v_mul_f32 v58, v40, v56
  v_mul_f32 v59, v41, v56
  v_fma_f32 v88, v88, v24, v58
  v_fma_f32 v89, v89, v25, v59
  v_cvt_pk_bf16_f32 v52, v88, v89
  v_mul_f32 v60, v42, v56
  v_mul_f32 v61, v43, v56
  v_fma_f32 v90, v90, v26, v60
  v_fma_f32 v91, v91, v27, v61
  v_cvt_pk_bf16_f32 v53, v90, v91
  v_mul_f32 v58, v44, v56
  v_mul_f32 v59, v45, v56
  v_fma_f32 v92, v92, v28, v58
  v_fma_f32 v93, v93, v29, v59
  v_cvt_pk_bf16_f32 v54, v92, v93
  v_mul_f32 v60, v46, v56
  v_mul_f32 v61, v47, v56
  v_fma_f32 v94, v94, v30, v60
  v_fma_f32 v95, v95, v31, v61
  v_cvt_pk_bf16_f32 v55, v94, v95
  s_add_u32 s49, s48, 1536
  buffer_store_dwordx4 v[52:55], v10, s[28:31], s49 offen sc1
  ds_read_b128 v[16:19], v11 offset:256
  ds_read_b128 v[32:35], v11 offset:768
  ds_read_b128 v[20:23], v11 offset:288
  ds_read_b128 v[36:39], v11 offset:800
  ds_read_b128 v[24:27], v11 offset:320
  ds_read_b128 v[40:43], v11 offset:832
  ds_read_b128 v[28:31], v11 offset:352
  ds_read_b128 v[44:47], v11 offset:864
  s_waitcnt lgkmcnt(0)
  v_mul_f32 v58, v32, v56
  v_mul_f32 v59, v33, v56
  v_fma_f32 v96, v96, v16, v58
  v_fma_f32 v97, v97, v17, v59
  v_cvt_pk_bf16_f32 v48, v96, v97
  v_mul_f32 v60, v34, v56
  v_mul_f32 v61, v35, v56
  v_fma_f32 v98, v98, v18, v60
  v_fma_f32 v99, v99, v19, v61
  v_cvt_pk_bf16_f32 v49, v98, v99
  v_mul_f32 v58, v36, v56
  v_mul_f32 v59, v37, v56
  v_fma_f32 v100, v100, v20, v58
  v_fma_f32 v101, v101, v21, v59
  v_cvt_pk_bf16_f32 v50, v100, v101
  v_mul_f32 v60, v38, v56
  v_mul_f32 v61, v39, v56
  v_fma_f32 v102, v102, v22, v60
  v_fma_f32 v103, v103, v23, v61
  v_cvt_pk_bf16_f32 v51, v102, v103
  s_add_u32 s49, s48, 2048
  buffer_store_dwordx4 v[48:51], v10, s[28:31], s49 offen sc1
  v_mul_f32 v58, v40, v56
  v_mul_f32 v59, v41, v56
  v_fma_f32 v104, v104, v24, v58
  v_fma_f32 v105, v105, v25, v59
  v_cvt_pk_bf16_f32 v52, v104, v105
  v_mul_f32 v60, v42, v56
  v_mul_f32 v61, v43, v56
  v_fma_f32 v106, v106, v26, v60
  v_fma_f32 v107, v107, v27, v61
  v_cvt_pk_bf16_f32 v53, v106, v107
  v_mul_f32 v58, v44, v56
  v_mul_f32 v59, v45, v56
  v_fma_f32 v108, v108, v28, v58
  v_fma_f32 v109, v109, v29, v59
  v_cvt_pk_bf16_f32 v54, v108, v109
  v_mul_f32 v60, v46, v56
  v_mul_f32 v61, v47, v56
  v_fma_f32 v110, v110, v30, v60
  v_fma_f32 v111, v111, v31, v61
  v_cvt_pk_bf16_f32 v55, v110, v111
  s_add_u32 s49, s48, 2560
  buffer_store_dwordx4 v[52:55], v10, s[28:31], s49 offen sc1
  ds_read_b128 v[16:19], v11 offset:384
  ds_read_b128 v[32:35], v11 offset:896
  ds_read_b128 v[20:23], v11 offset:416
  ds_read_b128 v[36:39], v11 offset:928
  ds_read_b128 v[24:27], v11 offset:448
  ds_read_b128 v[40:43], v11 offset:960
  ds_read_b128 v[28:31], v11 offset:480
  ds_read_b128 v[44:47], v11 offset:992
  s_waitcnt lgkmcnt(0)
  v_mul_f32 v58, v32, v56
  v_mul_f32 v59, v33, v56
  v_fma_f32 v112, v112, v16, v58
  v_fma_f32 v113, v113, v17, v59
  v_cvt_pk_bf16_f32 v48, v112, v113
  v_mul_f32 v60, v34, v56
  v_mul_f32 v61, v35, v56
  v_fma_f32 v114, v114, v18, v60
  v_fma_f32 v115, v115, v19, v61
  v_cvt_pk_bf16_f32 v49, v114, v115
  v_mul_f32 v58, v36, v56
  v_mul_f32 v59, v37, v56
  v_fma_f32 v116, v116, v20, v58
  v_fma_f32 v117, v117, v21, v59
  v_cvt_pk_bf16_f32 v50, v116, v117
  v_mul_f32 v60, v38, v56
  v_mul_f32 v61, v39, v56
  v_fma_f32 v118, v118, v22, v60
  v_fma_f32 v119, v119, v23, v61
  v_cvt_pk_bf16_f32 v51, v118, v119
  s_add_u32 s49, s48, 3072
  buffer_store_dwordx4 v[48:51], v10, s[28:31], s49 offen sc1
  v_mul_f32 v58, v40, v56
  v_mul_f32 v59, v41, v56
  v_fma_f32 v120, v120, v24, v58
  v_fma_f32 v121, v121, v25, v59
  v_cvt_pk_bf16_f32 v52, v120, v121
  v_mul_f32 v60, v42, v56
  v_mul_f32 v61, v43, v56
  v_fma_f32 v122, v122, v26, v60
  v_fma_f32 v123, v123, v27, v61
  v_cvt_pk_bf16_f32 v53, v122, v123
  v_mul_f32 v58, v44, v56
  v_mul_f32 v59, v45, v56
  v_fma_f32 v124, v124, v28, v58
  v_fma_f32 v125, v125, v29, v59
  v_cvt_pk_bf16_f32 v54, v124, v125
  v_mul_f32 v60, v46, v56
  v_mul_f32 v61, v47, v56
  v_fma_f32 v126, v126, v30, v60
  v_fma_f32 v127, v127, v31, v61
  v_cvt_pk_bf16_f32 v55, v126, v127
  s_add_u32 s49, s48, 3584
  buffer_store_dwordx4 v[52:55], v10, s[28:31], s49 offen sc1
  s_barrier
  s_lshl_b32 s48, s55, 8
  s_lshl_b32 s49, s26, 2
  s_add_u32 s48, s48, s49
  s_add_u32 s48, s48, 16777344
  s_waitcnt vmcnt(0)
  v_mov_b32 v12, s40
  v_mov_b32 v13, 0
  s_mov_b64 exec, 1
  buffer_store_dword v12, v13, s[28:31], s48 offen sc1
  s_mov_b64 exec, -1
  s_branch L_s2_idle
L_role_w3:
  v_and_b32 v10, 31, v0
  v_lshrrev_b32 v11, 5, v0
  v_bfe_u32 v12, v0, 1, 3
  v_xor_b32 v12, v11, v12
  v_lshlrev_b32 v12, 4, v12
  v_lshl_or_b32 v152, v10, 7, v12
  v_add_u32 v152, 0, v152
  v_xor_b32 v153, 32, v152
  v_xor_b32 v154, 64, v152
  v_xor_b32 v155, 96, v152
  v_mov_b32 v156, 0
  v_mov_b32 v157, 0
  v_mov_b32 v158, 0
  v_mov_b32 v159, 0
  v_mov_b32 v160, 0
  v_mov_b32 v161, 0
  v_mov_b32 v162, 0
  v_mov_b32 v163, 0
  s_waitcnt lgkmcnt(0)
  s_mov_b32 s28, s24
  s_and_b32 s29, s25, 0xffff
  s_mov_b32 s30, 17104896
  s_mov_b32 s31, 0x20000
  s_mov_b32 s32, s22
  s_and_b32 s33, s23, 0xffff
  s_mov_b32 s34, 256
  s_mov_b32 s35, 0x20000
  v_mov_b32 v2, 0
  s_cmp_lg_u32 s2, 0
  s_cbranch_scc1 L_nc_np
  s_memrealtime s[60:61]
  s_waitcnt lgkmcnt(0)
  s_or_b32 s60, s60, 1
  v_mov_b32 v1, s60
  s_mov_b64 exec, 1
  buffer_store_dword v1, v2, s[32:35], 0 offen sc1
  s_mov_b64 exec, -1
L_nc_np:
  s_barrier
  v_mov_b32 v12, 161808
  s_mov_b32 s58, 0
L_wsp_13:
  ds_read_b64 v[10:11], v12
  s_add_u32 s58, s58, 1
  s_waitcnt lgkmcnt(0)
  v_min_u32 v13, v10, v11
  s_nop 0
  v_readfirstlane_b32 s57, v13
  s_cmp_ge_u32 s58, 0x100000
  s_cbranch_scc1 L_wok_14
  s_cmp_lt_u32 s57, 1
  s_cbranch_scc1 L_wsp_13
L_wok_14:
  ds_read_b128 v[16:19], v152 offset:0
  ds_read_b128 v[20:23], v152 offset:4096
  ds_read_b128 v[24:27], v153 offset:0
  ds_read_b128 v[28:31], v153 offset:4096
  ds_read_b128 v[32:35], v154 offset:0
  ds_read_b128 v[36:39], v154 offset:4096
  ds_read_b128 v[40:43], v155 offset:0
  ds_read_b128 v[44:47], v155 offset:4096
  s_waitcnt lgkmcnt(7)
  v_dot2c_f32_bf16 v156, s41, v16
  v_dot2c_f32_bf16 v158, v16, v16
  v_dot2c_f32_bf16 v157, s41, v17
  v_dot2c_f32_bf16 v159, v17, v17
  v_dot2c_f32_bf16 v156, s41, v18
  v_dot2c_f32_bf16 v158, v18, v18
  v_dot2c_f32_bf16 v157, s41, v19
  v_dot2c_f32_bf16 v159, v19, v19
  s_waitcnt lgkmcnt(6)
  v_dot2c_f32_bf16 v160, s41, v20
  v_dot2c_f32_bf16 v162, v20, v20
  v_dot2c_f32_bf16 v161, s41, v21
  v_dot2c_f32_bf16 v163, v21, v21
  v_dot2c_f32_bf16 v160, s41, v22
  v_dot2c_f32_bf16 v162, v22, v22
  v_dot2c_f32_bf16 v161, s41, v23
  v_dot2c_f32_bf16 v163, v23, v23
  s_waitcnt lgkmcnt(5)
  v_dot2c_f32_bf16 v156, s41, v24
  v_dot2c_f32_bf16 v158, v24, v24
  v_dot2c_f32_bf16 v157, s41, v25
  v_dot2c_f32_bf16 v159, v25, v25
  v_dot2c_f32_bf16 v156, s41, v26
  v_dot2c_f32_bf16 v158, v26, v26
  v_dot2c_f32_bf16 v157, s41, v27
  v_dot2c_f32_bf16 v159, v27, v27
  s_waitcnt lgkmcnt(4)
  v_dot2c_f32_bf16 v160, s41, v28
  v_dot2c_f32_bf16 v162, v28, v28
  v_dot2c_f32_bf16 v161, s41, v29
  v_dot2c_f32_bf16 v163, v29, v29
  v_dot2c_f32_bf16 v160, s41, v30
  v_dot2c_f32_bf16 v162, v30, v30
  v_dot2c_f32_bf16 v161, s41, v31
  v_dot2c_f32_bf16 v163, v31, v31
  s_waitcnt lgkmcnt(3)
  v_dot2c_f32_bf16 v156, s41, v32
  v_dot2c_f32_bf16 v158, v32, v32
  v_dot2c_f32_bf16 v157, s41, v33
  v_dot2c_f32_bf16 v159, v33, v33
  v_dot2c_f32_bf16 v156, s41, v34
  v_dot2c_f32_bf16 v158, v34, v34
  v_dot2c_f32_bf16 v157, s41, v35
  v_dot2c_f32_bf16 v159, v35, v35
  s_waitcnt lgkmcnt(2)
  v_dot2c_f32_bf16 v160, s41, v36
  v_dot2c_f32_bf16 v162, v36, v36
  v_dot2c_f32_bf16 v161, s41, v37
  v_dot2c_f32_bf16 v163, v37, v37
  v_dot2c_f32_bf16 v160, s41, v38
  v_dot2c_f32_bf16 v162, v38, v38
  v_dot2c_f32_bf16 v161, s41, v39
  v_dot2c_f32_bf16 v163, v39, v39
  s_waitcnt lgkmcnt(1)
  v_dot2c_f32_bf16 v156, s41, v40
  v_dot2c_f32_bf16 v158, v40, v40
  v_dot2c_f32_bf16 v157, s41, v41
  v_dot2c_f32_bf16 v159, v41, v41
  v_dot2c_f32_bf16 v156, s41, v42
  v_dot2c_f32_bf16 v158, v42, v42
  v_dot2c_f32_bf16 v157, s41, v43
  v_dot2c_f32_bf16 v159, v43, v43
  s_waitcnt lgkmcnt(0)
  v_dot2c_f32_bf16 v160, s41, v44
  v_dot2c_f32_bf16 v162, v44, v44
  v_dot2c_f32_bf16 v161, s41, v45
  v_dot2c_f32_bf16 v163, v45, v45
  v_dot2c_f32_bf16 v160, s41, v46
  v_dot2c_f32_bf16 v162, v46, v46
  v_dot2c_f32_bf16 v161, s41, v47
  v_dot2c_f32_bf16 v163, v47, v47
  v_mov_b32 v12, 161808
  s_mov_b32 s58, 0
L_wsp_15:
  ds_read_b64 v[10:11], v12
  s_add_u32 s58, s58, 1
  s_waitcnt lgkmcnt(0)
  v_min_u32 v13, v10, v11
  s_nop 0
  v_readfirstlane_b32 s57, v13
  s_cmp_ge_u32 s58, 0x100000
  s_cbranch_scc1 L_wok_16
  s_cmp_lt_u32 s57, 2
  s_cbranch_scc1 L_wsp_15
L_wok_16:
  ds_read_b128 v[16:19], v152 offset:16384
  ds_read_b128 v[20:23], v152 offset:20480
  ds_read_b128 v[24:27], v153 offset:16384
  ds_read_b128 v[28:31], v153 offset:20480
  ds_read_b128 v[32:35], v154 offset:16384
  ds_read_b128 v[36:39], v154 offset:20480
  ds_read_b128 v[40:43], v155 offset:16384
  ds_read_b128 v[44:47], v155 offset:20480
  s_waitcnt lgkmcnt(7)
  v_dot2c_f32_bf16 v156, s41, v16
  v_dot2c_f32_bf16 v158, v16, v16
  v_dot2c_f32_bf16 v157, s41, v17
  v_dot2c_f32_bf16 v159, v17, v17
  v_dot2c_f32_bf16 v156, s41, v18
  v_dot2c_f32_bf16 v158, v18, v18
  v_dot2c_f32_bf16 v157, s41, v19
  v_dot2c_f32_bf16 v159, v19, v19
  s_waitcnt lgkmcnt(6)
  v_dot2c_f32_bf16 v160, s41, v20
  v_dot2c_f32_bf16 v162, v20, v20
  v_dot2c_f32_bf16 v161, s41, v21
  v_dot2c_f32_bf16 v163, v21, v21
  v_dot2c_f32_bf16 v160, s41, v22
  v_dot2c_f32_bf16 v162, v22, v22
  v_dot2c_f32_bf16 v161, s41, v23
  v_dot2c_f32_bf16 v163, v23, v23
  s_waitcnt lgkmcnt(5)
  v_dot2c_f32_bf16 v156, s41, v24
  v_dot2c_f32_bf16 v158, v24, v24
  v_dot2c_f32_bf16 v157, s41, v25
  v_dot2c_f32_bf16 v159, v25, v25
  v_dot2c_f32_bf16 v156, s41, v26
  v_dot2c_f32_bf16 v158, v26, v26
  v_dot2c_f32_bf16 v157, s41, v27
  v_dot2c_f32_bf16 v159, v27, v27
  s_waitcnt lgkmcnt(4)
  v_dot2c_f32_bf16 v160, s41, v28
  v_dot2c_f32_bf16 v162, v28, v28
  v_dot2c_f32_bf16 v161, s41, v29
  v_dot2c_f32_bf16 v163, v29, v29
  v_dot2c_f32_bf16 v160, s41, v30
  v_dot2c_f32_bf16 v162, v30, v30
  v_dot2c_f32_bf16 v161, s41, v31
  v_dot2c_f32_bf16 v163, v31, v31
  s_waitcnt lgkmcnt(3)
  v_dot2c_f32_bf16 v156, s41, v32
  v_dot2c_f32_bf16 v158, v32, v32
  v_dot2c_f32_bf16 v157, s41, v33
  v_dot2c_f32_bf16 v159, v33, v33
  v_dot2c_f32_bf16 v156, s41, v34
  v_dot2c_f32_bf16 v158, v34, v34
  v_dot2c_f32_bf16 v157, s41, v35
  v_dot2c_f32_bf16 v159, v35, v35
  s_waitcnt lgkmcnt(2)
  v_dot2c_f32_bf16 v160, s41, v36
  v_dot2c_f32_bf16 v162, v36, v36
  v_dot2c_f32_bf16 v161, s41, v37
  v_dot2c_f32_bf16 v163, v37, v37
  v_dot2c_f32_bf16 v160, s41, v38
  v_dot2c_f32_bf16 v162, v38, v38
  v_dot2c_f32_bf16 v161, s41, v39
  v_dot2c_f32_bf16 v163, v39, v39
  s_waitcnt lgkmcnt(1)
  v_dot2c_f32_bf16 v156, s41, v40
  v_dot2c_f32_bf16 v158, v40, v40
  v_dot2c_f32_bf16 v157, s41, v41
  v_dot2c_f32_bf16 v159, v41, v41
  v_dot2c_f32_bf16 v156, s41, v42
  v_dot2c_f32_bf16 v158, v42, v42
  v_dot2c_f32_bf16 v157, s41, v43
  v_dot2c_f32_bf16 v159, v43, v43
  s_waitcnt lgkmcnt(0)
  v_dot2c_f32_bf16 v160, s41, v44
  v_dot2c_f32_bf16 v162, v44, v44
  v_dot2c_f32_bf16 v161, s41, v45
  v_dot2c_f32_bf16 v163, v45, v45
  v_dot2c_f32_bf16 v160, s41, v46
  v_dot2c_f32_bf16 v162, v46, v46
  v_dot2c_f32_bf16 v161, s41, v47
  v_dot2c_f32_bf16 v163, v47, v47
  v_mov_b32 v12, 161808
  s_mov_b32 s58, 0
L_wsp_17:
  ds_read_b64 v[10:11], v12
  s_add_u32 s58, s58, 1
  s_waitcnt lgkmcnt(0)
  v_min_u32 v13, v10, v11
  s_nop 0
  v_readfirstlane_b32 s57, v13
  s_cmp_ge_u32 s58, 0x100000
  s_cbranch_scc1 L_wok_18
  s_cmp_lt_u32 s57, 3
  s_cbranch_scc1 L_wsp_17
L_wok_18:
  ds_read_b128 v[16:19], v152 offset:32768
  ds_read_b128 v[20:23], v152 offset:36864
  ds_read_b128 v[24:27], v153 offset:32768
  ds_read_b128 v[28:31], v153 offset:36864
  ds_read_b128 v[32:35], v154 offset:32768
  ds_read_b128 v[36:39], v154 offset:36864
  ds_read_b128 v[40:43], v155 offset:32768
  ds_read_b128 v[44:47], v155 offset:36864
  s_waitcnt lgkmcnt(7)
  v_dot2c_f32_bf16 v156, s41, v16
  v_dot2c_f32_bf16 v158, v16, v16
  v_dot2c_f32_bf16 v157, s41, v17
  v_dot2c_f32_bf16 v159, v17, v17
  v_dot2c_f32_bf16 v156, s41, v18
  v_dot2c_f32_bf16 v158, v18, v18
  v_dot2c_f32_bf16 v157, s41, v19
  v_dot2c_f32_bf16 v159, v19, v19
  s_waitcnt lgkmcnt(6)
  v_dot2c_f32_bf16 v160, s41, v20
  v_dot2c_f32_bf16 v162, v20, v20
  v_dot2c_f32_bf16 v161, s41, v21
  v_dot2c_f32_bf16 v163, v21, v21
  v_dot2c_f32_bf16 v160, s41, v22
  v_dot2c_f32_bf16 v162, v22, v22
  v_dot2c_f32_bf16 v161, s41, v23
  v_dot2c_f32_bf16 v163, v23, v23
  s_waitcnt lgkmcnt(5)
  v_dot2c_f32_bf16 v156, s41, v24
  v_dot2c_f32_bf16 v158, v24, v24
  v_dot2c_f32_bf16 v157, s41, v25
  v_dot2c_f32_bf16 v159, v25, v25
  v_dot2c_f32_bf16 v156, s41, v26
  v_dot2c_f32_bf16 v158, v26, v26
  v_dot2c_f32_bf16 v157, s41, v27
  v_dot2c_f32_bf16 v159, v27, v27
  s_waitcnt lgkmcnt(4)
  v_dot2c_f32_bf16 v160, s41, v28
  v_dot2c_f32_bf16 v162, v28, v28
  v_dot2c_f32_bf16 v161, s41, v29
  v_dot2c_f32_bf16 v163, v29, v29
  v_dot2c_f32_bf16 v160, s41, v30
  v_dot2c_f32_bf16 v162, v30, v30
  v_dot2c_f32_bf16 v161, s41, v31
  v_dot2c_f32_bf16 v163, v31, v31
  s_waitcnt lgkmcnt(3)
  v_dot2c_f32_bf16 v156, s41, v32
  v_dot2c_f32_bf16 v158, v32, v32
  v_dot2c_f32_bf16 v157, s41, v33
  v_dot2c_f32_bf16 v159, v33, v33
  v_dot2c_f32_bf16 v156, s41, v34
  v_dot2c_f32_bf16 v158, v34, v34
  v_dot2c_f32_bf16 v157, s41, v35
  v_dot2c_f32_bf16 v159, v35, v35
  s_waitcnt lgkmcnt(2)
  v_dot2c_f32_bf16 v160, s41, v36
  v_dot2c_f32_bf16 v162, v36, v36
  v_dot2c_f32_bf16 v161, s41, v37
  v_dot2c_f32_bf16 v163, v37, v37
  v_dot2c_f32_bf16 v160, s41, v38
  v_dot2c_f32_bf16 v162, v38, v38
  v_dot2c_f32_bf16 v161, s41, v39
  v_dot2c_f32_bf16 v163, v39, v39
  s_waitcnt lgkmcnt(1)
  v_dot2c_f32_bf16 v156, s41, v40
  v_dot2c_f32_bf16 v158, v40, v40
  v_dot2c_f32_bf16 v157, s41, v41
  v_dot2c_f32_bf16 v159, v41, v41
  v_dot2c_f32_bf16 v156, s41, v42
  v_dot2c_f32_bf16 v158, v42, v42
  v_dot2c_f32_bf16 v157, s41, v43
  v_dot2c_f32_bf16 v159, v43, v43
  s_waitcnt lgkmcnt(0)
  v_dot2c_f32_bf16 v160, s41, v44
  v_dot2c_f32_bf16 v162, v44, v44
  v_dot2c_f32_bf16 v161, s41, v45
  v_dot2c_f32_bf16 v163, v45, v45
  v_dot2c_f32_bf16 v160, s41, v46
  v_dot2c_f32_bf16 v162, v46, v46
  v_dot2c_f32_bf16 v161, s41, v47
  v_dot2c_f32_bf16 v163, v47, v47
  buffer_load_dword v1, v2, s[32:35], 0 offen sc1
  v_mov_b32 v12, 161808
  s_mov_b32 s58, 0
L_wsp_19:
  ds_read_b64 v[10:11], v12
  s_add_u32 s58, s58, 1
  s_waitcnt lgkmcnt(0)
  v_min_u32 v13, v10, v11
  s_nop 0
  v_readfirstlane_b32 s57, v13
  s_cmp_ge_u32 s58, 0x100000
  s_cbranch_scc1 L_wok_20
  s_cmp_lt_u32 s57, 4
  s_cbranch_scc1 L_wsp_19
L_wok_20:
  ds_read_b128 v[16:19], v152 offset:49152
  ds_read_b128 v[20:23], v152 offset:53248
  ds_read_b128 v[24:27], v153 offset:49152
  ds_read_b128 v[28:31], v153 offset:53248
  ds_read_b128 v[32:35], v154 offset:49152
  ds_read_b128 v[36:39], v154 offset:53248
  ds_read_b128 v[40:43], v155 offset:49152
  ds_read_b128 v[44:47], v155 offset:53248
  s_waitcnt lgkmcnt(7)
  v_dot2c_f32_bf16 v156, s41, v16
  v_dot2c_f32_bf16 v158, v16, v16
  v_dot2c_f32_bf16 v157, s41, v17
  v_dot2c_f32_bf16 v159, v17, v17
  v_dot2c_f32_bf16 v156, s41, v18
  v_dot2c_f32_bf16 v158, v18, v18
  v_dot2c_f32_bf16 v157, s41, v19
  v_dot2c_f32_bf16 v159, v19, v19
  s_waitcnt lgkmcnt(6)
  v_dot2c_f32_bf16 v160, s41, v20
  v_dot2c_f32_bf16 v162, v20, v20
  v_dot2c_f32_bf16 v161, s41, v21
  v_dot2c_f32_bf16 v163, v21, v21
  v_dot2c_f32_bf16 v160, s41, v22
  v_dot2c_f32_bf16 v162, v22, v22
  v_dot2c_f32_bf16 v161, s41, v23
  v_dot2c_f32_bf16 v163, v23, v23
  s_waitcnt lgkmcnt(5)
  v_dot2c_f32_bf16 v156, s41, v24
  v_dot2c_f32_bf16 v158, v24, v24
  v_dot2c_f32_bf16 v157, s41, v25
  v_dot2c_f32_bf16 v159, v25, v25
  v_dot2c_f32_bf16 v156, s41, v26
  v_dot2c_f32_bf16 v158, v26, v26
  v_dot2c_f32_bf16 v157, s41, v27
  v_dot2c_f32_bf16 v159, v27, v27
  s_waitcnt lgkmcnt(4)
  v_dot2c_f32_bf16 v160, s41, v28
  v_dot2c_f32_bf16 v162, v28, v28
  v_dot2c_f32_bf16 v161, s41, v29
  v_dot2c_f32_bf16 v163, v29, v29
  v_dot2c_f32_bf16 v160, s41, v30
  v_dot2c_f32_bf16 v162, v30, v30
  v_dot2c_f32_bf16 v161, s41, v31
  v_dot2c_f32_bf16 v163, v31, v31
  s_waitcnt lgkmcnt(3)
  v_dot2c_f32_bf16 v156, s41, v32
  v_dot2c_f32_bf16 v158, v32, v32
  v_dot2c_f32_bf16 v157, s41, v33
  v_dot2c_f32_bf16 v159, v33, v33
  v_dot2c_f32_bf16 v156, s41, v34
  v_dot2c_f32_bf16 v158, v34, v34
  v_dot2c_f32_bf16 v157, s41, v35
  v_dot2c_f32_bf16 v159, v35, v35
  s_waitcnt lgkmcnt(2)
  v_dot2c_f32_bf16 v160, s41, v36
  v_dot2c_f32_bf16 v162, v36, v36
  v_dot2c_f32_bf16 v161, s41, v37
  v_dot2c_f32_bf16 v163, v37, v37
  v_dot2c_f32_bf16 v160, s41, v38
  v_dot2c_f32_bf16 v162, v38, v38
  v_dot2c_f32_bf16 v161, s41, v39
  v_dot2c_f32_bf16 v163, v39, v39
  s_waitcnt lgkmcnt(1)
  v_dot2c_f32_bf16 v156, s41, v40
  v_dot2c_f32_bf16 v158, v40, v40
  v_dot2c_f32_bf16 v157, s41, v41
  v_dot2c_f32_bf16 v159, v41, v41
  v_dot2c_f32_bf16 v156, s41, v42
  v_dot2c_f32_bf16 v158, v42, v42
  v_dot2c_f32_bf16 v157, s41, v43
  v_dot2c_f32_bf16 v159, v43, v43
  s_waitcnt lgkmcnt(0)
  v_dot2c_f32_bf16 v160, s41, v44
  v_dot2c_f32_bf16 v162, v44, v44
  v_dot2c_f32_bf16 v161, s41, v45
  v_dot2c_f32_bf16 v163, v45, v45
  v_dot2c_f32_bf16 v160, s41, v46
  v_dot2c_f32_bf16 v162, v46, v46
  v_dot2c_f32_bf16 v161, s41, v47
  v_dot2c_f32_bf16 v163, v47, v47
  v_mov_b32 v12, 161808
  s_mov_b32 s58, 0
L_wsp_21:
  ds_read_b64 v[10:11], v12
  s_add_u32 s58, s58, 1
  s_waitcnt lgkmcnt(0)
  v_min_u32 v13, v10, v11
  s_nop 0
  v_readfirstlane_b32 s57, v13
  s_cmp_ge_u32 s58, 0x100000
  s_cbranch_scc1 L_wok_22
  s_cmp_lt_u32 s57, 5
  s_cbranch_scc1 L_wsp_21
L_wok_22:
  v_add_u32 v152, 0x10000, v152
  v_add_u32 v153, 0x10000, v153
  v_add_u32 v154, 0x10000, v154
  v_add_u32 v155, 0x10000, v155
  ds_read_b128 v[16:19], v152 offset:0
  ds_read_b128 v[20:23], v152 offset:4096
  ds_read_b128 v[24:27], v153 offset:0
  ds_read_b128 v[28:31], v153 offset:4096
  ds_read_b128 v[32:35], v154 offset:0
  ds_read_b128 v[36:39], v154 offset:4096
  ds_read_b128 v[40:43], v155 offset:0
  ds_read_b128 v[44:47], v155 offset:4096
  s_waitcnt lgkmcnt(7)
  v_dot2c_f32_bf16 v156, s41, v16
  v_dot2c_f32_bf16 v158, v16, v16
  v_dot2c_f32_bf16 v157, s41, v17
  v_dot2c_f32_bf16 v159, v17, v17
  v_dot2c_f32_bf16 v156, s41, v18
  v_dot2c_f32_bf16 v158, v18, v18
  v_dot2c_f32_bf16 v157, s41, v19
  v_dot2c_f32_bf16 v159, v19, v19
  s_waitcnt lgkmcnt(6)
  v_dot2c_f32_bf16 v160, s41, v20
  v_dot2c_f32_bf16 v162, v20, v20
  v_dot2c_f32_bf16 v161, s41, v21
  v_dot2c_f32_bf16 v163, v21, v21
  v_dot2c_f32_bf16 v160, s41, v22
  v_dot2c_f32_bf16 v162, v22, v22
  v_dot2c_f32_bf16 v161, s41, v23
  v_dot2c_f32_bf16 v163, v23, v23
  s_waitcnt lgkmcnt(5)
  v_dot2c_f32_bf16 v156, s41, v24
  v_dot2c_f32_bf16 v158, v24, v24
  v_dot2c_f32_bf16 v157, s41, v25
  v_dot2c_f32_bf16 v159, v25, v25
  v_dot2c_f32_bf16 v156, s41, v26
  v_dot2c_f32_bf16 v158, v26, v26
  v_dot2c_f32_bf16 v157, s41, v27
  v_dot2c_f32_bf16 v159, v27, v27
  s_waitcnt lgkmcnt(4)
  v_dot2c_f32_bf16 v160, s41, v28
  v_dot2c_f32_bf16 v162, v28, v28
  v_dot2c_f32_bf16 v161, s41, v29
  v_dot2c_f32_bf16 v163, v29, v29
  v_dot2c_f32_bf16 v160, s41, v30
  v_dot2c_f32_bf16 v162, v30, v30
  v_dot2c_f32_bf16 v161, s41, v31
  v_dot2c_f32_bf16 v163, v31, v31
  s_waitcnt lgkmcnt(3)
  v_dot2c_f32_bf16 v156, s41, v32
  v_dot2c_f32_bf16 v158, v32, v32
  v_dot2c_f32_bf16 v157, s41, v33
  v_dot2c_f32_bf16 v159, v33, v33
  v_dot2c_f32_bf16 v156, s41, v34
  v_dot2c_f32_bf16 v158, v34, v34
  v_dot2c_f32_bf16 v157, s41, v35
  v_dot2c_f32_bf16 v159, v35, v35
  s_waitcnt lgkmcnt(2)
  v_dot2c_f32_bf16 v160, s41, v36
  v_dot2c_f32_bf16 v162, v36, v36
  v_dot2c_f32_bf16 v161, s41, v37
  v_dot2c_f32_bf16 v163, v37, v37
  v_dot2c_f32_bf16 v160, s41, v38
  v_dot2c_f32_bf16 v162, v38, v38
  v_dot2c_f32_bf16 v161, s41, v39
  v_dot2c_f32_bf16 v163, v39, v39
  s_waitcnt lgkmcnt(1)
  v_dot2c_f32_bf16 v156, s41, v40
  v_dot2c_f32_bf16 v158, v40, v40
  v_dot2c_f32_bf16 v157, s41, v41
  v_dot2c_f32_bf16 v159, v41, v41
  v_dot2c_f32_bf16 v156, s41, v42
  v_dot2c_f32_bf16 v158, v42, v42
  v_dot2c_f32_bf16 v157, s41, v43
  v_dot2c_f32_bf16 v159, v43, v43
  s_waitcnt lgkmcnt(0)
  v_dot2c_f32_bf16 v160, s41, v44
  v_dot2c_f32_bf16 v162, v44, v44
  v_dot2c_f32_bf16 v161, s41, v45
  v_dot2c_f32_bf16 v163, v45, v45
  v_dot2c_f32_bf16 v160, s41, v46
  v_dot2c_f32_bf16 v162, v46, v46
  v_dot2c_f32_bf16 v161, s41, v47
  v_dot2c_f32_bf16 v163, v47, v47
  v_mov_b32 v12, 161808
  s_mov_b32 s58, 0
L_wsp_23:
  ds_read_b64 v[10:11], v12
  s_add_u32 s58, s58, 1
  s_waitcnt lgkmcnt(0)
  v_min_u32 v13, v10, v11
  s_nop 0
  v_readfirstlane_b32 s57, v13
  s_cmp_ge_u32 s58, 0x100000
  s_cbranch_scc1 L_wok_24
  s_cmp_lt_u32 s57, 6
  s_cbranch_scc1 L_wsp_23
L_wok_24:
  ds_read_b128 v[16:19], v152 offset:16384
  ds_read_b128 v[20:23], v152 offset:20480
  ds_read_b128 v[24:27], v153 offset:16384
  ds_read_b128 v[28:31], v153 offset:20480
  ds_read_b128 v[32:35], v154 offset:16384
  ds_read_b128 v[36:39], v154 offset:20480
  ds_read_b128 v[40:43], v155 offset:16384
  ds_read_b128 v[44:47], v155 offset:20480
  s_waitcnt lgkmcnt(7)
  v_dot2c_f32_bf16 v156, s41, v16
  v_dot2c_f32_bf16 v158, v16, v16
  v_dot2c_f32_bf16 v157, s41, v17
  v_dot2c_f32_bf16 v159, v17, v17
  v_dot2c_f32_bf16 v156, s41, v18
  v_dot2c_f32_bf16 v158, v18, v18
  v_dot2c_f32_bf16 v157, s41, v19
  v_dot2c_f32_bf16 v159, v19, v19
  s_waitcnt lgkmcnt(6)
  v_dot2c_f32_bf16 v160, s41, v20
  v_dot2c_f32_bf16 v162, v20, v20
  v_dot2c_f32_bf16 v161, s41, v21
  v_dot2c_f32_bf16 v163, v21, v21
  v_dot2c_f32_bf16 v160, s41, v22
  v_dot2c_f32_bf16 v162, v22, v22
  v_dot2c_f32_bf16 v161, s41, v23
  v_dot2c_f32_bf16 v163, v23, v23
  s_waitcnt lgkmcnt(5)
  v_dot2c_f32_bf16 v156, s41, v24
  v_dot2c_f32_bf16 v158, v24, v24
  v_dot2c_f32_bf16 v157, s41, v25
  v_dot2c_f32_bf16 v159, v25, v25
  v_dot2c_f32_bf16 v156, s41, v26
  v_dot2c_f32_bf16 v158, v26, v26
  v_dot2c_f32_bf16 v157, s41, v27
  v_dot2c_f32_bf16 v159, v27, v27
  s_waitcnt lgkmcnt(4)
  v_dot2c_f32_bf16 v160, s41, v28
  v_dot2c_f32_bf16 v162, v28, v28
  v_dot2c_f32_bf16 v161, s41, v29
  v_dot2c_f32_bf16 v163, v29, v29
  v_dot2c_f32_bf16 v160, s41, v30
  v_dot2c_f32_bf16 v162, v30, v30
  v_dot2c_f32_bf16 v161, s41, v31
  v_dot2c_f32_bf16 v163, v31, v31
  s_waitcnt lgkmcnt(3)
  v_dot2c_f32_bf16 v156, s41, v32
  v_dot2c_f32_bf16 v158, v32, v32
  v_dot2c_f32_bf16 v157, s41, v33
  v_dot2c_f32_bf16 v159, v33, v33
  v_dot2c_f32_bf16 v156, s41, v34
  v_dot2c_f32_bf16 v158, v34, v34
  v_dot2c_f32_bf16 v157, s41, v35
  v_dot2c_f32_bf16 v159, v35, v35
  s_waitcnt lgkmcnt(2)
  v_dot2c_f32_bf16 v160, s41, v36
  v_dot2c_f32_bf16 v162, v36, v36
  v_dot2c_f32_bf16 v161, s41, v37
  v_dot2c_f32_bf16 v163, v37, v37
  v_dot2c_f32_bf16 v160, s41, v38
  v_dot2c_f32_bf16 v162, v38, v38
  v_dot2c_f32_bf16 v161, s41, v39
  v_dot2c_f32_bf16 v163, v39, v39
  s_waitcnt lgkmcnt(1)
  v_dot2c_f32_bf16 v156, s41, v40
  v_dot2c_f32_bf16 v158, v40, v40
  v_dot2c_f32_bf16 v157, s41, v41
  v_dot2c_f32_bf16 v159, v41, v41
  v_dot2c_f32_bf16 v156, s41, v42
  v_dot2c_f32_bf16 v158, v42, v42
  v_dot2c_f32_bf16 v157, s41, v43
  v_dot2c_f32_bf16 v159, v43, v43
  s_waitcnt lgkmcnt(0)
  v_dot2c_f32_bf16 v160, s41, v44
  v_dot2c_f32_bf16 v162, v44, v44
  v_dot2c_f32_bf16 v161, s41, v45
  v_dot2c_f32_bf16 v163, v45, v45
  v_dot2c_f32_bf16 v160, s41, v46
  v_dot2c_f32_bf16 v162, v46, v46
  v_dot2c_f32_bf16 v161, s41, v47
  v_dot2c_f32_bf16 v163, v47, v47
  v_mov_b32 v12, 161808
  s_mov_b32 s58, 0
L_wsp_25:
  ds_read_b64 v[10:11], v12
  s_add_u32 s58, s58, 1
  s_waitcnt lgkmcnt(0)
  v_min_u32 v13, v10, v11
  s_nop 0
  v_readfirstlane_b32 s57, v13
  s_cmp_ge_u32 s58, 0x100000
  s_cbranch_scc1 L_wok_26
  s_cmp_lt_u32 s57, 7
  s_cbranch_scc1 L_wsp_25
L_wok_26:
  ds_read_b128 v[16:19], v152 offset:32768
  ds_read_b128 v[20:23], v152 offset:36864
  ds_read_b128 v[24:27], v153 offset:32768
  ds_read_b128 v[28:31], v153 offset:36864
  ds_read_b128 v[32:35], v154 offset:32768
  ds_read_b128 v[36:39], v154 offset:36864
  ds_read_b128 v[40:43], v155 offset:32768
  ds_read_b128 v[44:47], v155 offset:36864
  s_waitcnt lgkmcnt(7)
  v_dot2c_f32_bf16 v156, s41, v16
  v_dot2c_f32_bf16 v158, v16, v16
  v_dot2c_f32_bf16 v157, s41, v17
  v_dot2c_f32_bf16 v159, v17, v17
  v_dot2c_f32_bf16 v156, s41, v18
  v_dot2c_f32_bf16 v158, v18, v18
  v_dot2c_f32_bf16 v157, s41, v19
  v_dot2c_f32_bf16 v159, v19, v19
  s_waitcnt lgkmcnt(6)
  v_dot2c_f32_bf16 v160, s41, v20
  v_dot2c_f32_bf16 v162, v20, v20
  v_dot2c_f32_bf16 v161, s41, v21
  v_dot2c_f32_bf16 v163, v21, v21
  v_dot2c_f32_bf16 v160, s41, v22
  v_dot2c_f32_bf16 v162, v22, v22
  v_dot2c_f32_bf16 v161, s41, v23
  v_dot2c_f32_bf16 v163, v23, v23
  s_waitcnt lgkmcnt(5)
  v_dot2c_f32_bf16 v156, s41, v24
  v_dot2c_f32_bf16 v158, v24, v24
  v_dot2c_f32_bf16 v157, s41, v25
  v_dot2c_f32_bf16 v159, v25, v25
  v_dot2c_f32_bf16 v156, s41, v26
  v_dot2c_f32_bf16 v158, v26, v26
  v_dot2c_f32_bf16 v157, s41, v27
  v_dot2c_f32_bf16 v159, v27, v27
  s_waitcnt lgkmcnt(4)
  v_dot2c_f32_bf16 v160, s41, v28
  v_dot2c_f32_bf16 v162, v28, v28
  v_dot2c_f32_bf16 v161, s41, v29
  v_dot2c_f32_bf16 v163, v29, v29
  v_dot2c_f32_bf16 v160, s41, v30
  v_dot2c_f32_bf16 v162, v30, v30
  v_dot2c_f32_bf16 v161, s41, v31
  v_dot2c_f32_bf16 v163, v31, v31
  s_waitcnt lgkmcnt(3)
  v_dot2c_f32_bf16 v156, s41, v32
  v_dot2c_f32_bf16 v158, v32, v32
  v_dot2c_f32_bf16 v157, s41, v33
  v_dot2c_f32_bf16 v159, v33, v33
  v_dot2c_f32_bf16 v156, s41, v34
  v_dot2c_f32_bf16 v158, v34, v34
  v_dot2c_f32_bf16 v157, s41, v35
  v_dot2c_f32_bf16 v159, v35, v35
  s_waitcnt lgkmcnt(2)
  v_dot2c_f32_bf16 v160, s41, v36
  v_dot2c_f32_bf16 v162, v36, v36
  v_dot2c_f32_bf16 v161, s41, v37
  v_dot2c_f32_bf16 v163, v37, v37
  v_dot2c_f32_bf16 v160, s41, v38
  v_dot2c_f32_bf16 v162, v38, v38
  v_dot2c_f32_bf16 v161, s41, v39
  v_dot2c_f32_bf16 v163, v39, v39
  s_waitcnt lgkmcnt(1)
  v_dot2c_f32_bf16 v156, s41, v40
  v_dot2c_f32_bf16 v158, v40, v40
  v_dot2c_f32_bf16 v157, s41, v41
  v_dot2c_f32_bf16 v159, v41, v41
  v_dot2c_f32_bf16 v156, s41, v42
  v_dot2c_f32_bf16 v158, v42, v42
  v_dot2c_f32_bf16 v157, s41, v43
  v_dot2c_f32_bf16 v159, v43, v43
  s_waitcnt lgkmcnt(0)
  v_dot2c_f32_bf16 v160, s41, v44
  v_dot2c_f32_bf16 v162, v44, v44
  v_dot2c_f32_bf16 v161, s41, v45
  v_dot2c_f32_bf16 v163, v45, v45
  v_dot2c_f32_bf16 v160, s41, v46
  v_dot2c_f32_bf16 v162, v46, v46
  v_dot2c_f32_bf16 v161, s41, v47
  v_dot2c_f32_bf16 v163, v47, v47
  s_mov_b32 s62, 0
L_nc_chk:
  s_waitcnt vmcnt(0)
  v_readfirstlane_b32 s40, v1
  s_cmp_lg_u32 s40, 0
  s_cbranch_scc1 L_nc_got
  s_add_u32 s62, s62, 1
  s_cmp_ge_u32 s62, 8192
  s_cbranch_scc1 L_nc_got
  buffer_load_dword v1, v2, s[32:35], 0 offen sc1
  s_branch L_nc_chk
L_nc_got:
  v_mov_b32 v1, s40
  v_mov_b32 v2, 161792
  ds_write_b32 v2, v1
  v_mov_b32 v12, 161808
  s_mov_b32 s58, 0
L_wsp_27:
  ds_read_b64 v[10:11], v12
  s_add_u32 s58, s58, 1
  s_waitcnt lgkmcnt(0)
  v_min_u32 v13, v10, v11
  s_nop 0
  v_readfirstlane_b32 s57, v13
  s_cmp_ge_u32 s58, 0x100000
  s_cbranch_scc1 L_wok_28
  s_cmp_lt_u32 s57, 8
  s_cbranch_scc1 L_wsp_27
L_wok_28:
  ds_read_b128 v[16:19], v152 offset:49152
  ds_read_b128 v[20:23], v152 offset:53248
  ds_read_b128 v[24:27], v153 offset:49152
  ds_read_b128 v[28:31], v153 offset:53248
  ds_read_b128 v[32:35], v154 offset:49152
  ds_read_b128 v[36:39], v154 offset:53248
  ds_read_b128 v[40:43], v155 offset:49152
  ds_read_b128 v[44:47], v155 offset:53248
  s_waitcnt lgkmcnt(7)
  v_dot2c_f32_bf16 v156, s41, v16
  v_dot2c_f32_bf16 v158, v16, v16
  v_dot2c_f32_bf16 v157, s41, v17
  v_dot2c_f32_bf16 v159, v17, v17
  v_dot2c_f32_bf16 v156, s41, v18
  v_dot2c_f32_bf16 v158, v18, v18
  v_dot2c_f32_bf16 v157, s41, v19
  v_dot2c_f32_bf16 v159, v19, v19
  s_waitcnt lgkmcnt(6)
  v_dot2c_f32_bf16 v160, s41, v20
  v_dot2c_f32_bf16 v162, v20, v20
  v_dot2c_f32_bf16 v161, s41, v21
  v_dot2c_f32_bf16 v163, v21, v21
  v_dot2c_f32_bf16 v160, s41, v22
  v_dot2c_f32_bf16 v162, v22, v22
  v_dot2c_f32_bf16 v161, s41, v23
  v_dot2c_f32_bf16 v163, v23, v23
  s_waitcnt lgkmcnt(5)
  v_dot2c_f32_bf16 v156, s41, v24
  v_dot2c_f32_bf16 v158, v24, v24
  v_dot2c_f32_bf16 v157, s41, v25
  v_dot2c_f32_bf16 v159, v25, v25
  v_dot2c_f32_bf16 v156, s41, v26
  v_dot2c_f32_bf16 v158, v26, v26
  v_dot2c_f32_bf16 v157, s41, v27
  v_dot2c_f32_bf16 v159, v27, v27
  s_waitcnt lgkmcnt(4)
  v_dot2c_f32_bf16 v160, s41, v28
  v_dot2c_f32_bf16 v162, v28, v28
  v_dot2c_f32_bf16 v161, s41, v29
  v_dot2c_f32_bf16 v163, v29, v29
  v_dot2c_f32_bf16 v160, s41, v30
  v_dot2c_f32_bf16 v162, v30, v30
  v_dot2c_f32_bf16 v161, s41, v31
  v_dot2c_f32_bf16 v163, v31, v31
  s_waitcnt lgkmcnt(3)
  v_dot2c_f32_bf16 v156, s41, v32
  v_dot2c_f32_bf16 v158, v32, v32
  v_dot2c_f32_bf16 v157, s41, v33
  v_dot2c_f32_bf16 v159, v33, v33
  v_dot2c_f32_bf16 v156, s41, v34
  v_dot2c_f32_bf16 v158, v34, v34
  v_dot2c_f32_bf16 v157, s41, v35
  v_dot2c_f32_bf16 v159, v35, v35
  s_waitcnt lgkmcnt(2)
  v_dot2c_f32_bf16 v160, s41, v36
  v_dot2c_f32_bf16 v162, v36, v36
  v_dot2c_f32_bf16 v161, s41, v37
  v_dot2c_f32_bf16 v163, v37, v37
  v_dot2c_f32_bf16 v160, s41, v38
  v_dot2c_f32_bf16 v162, v38, v38
  v_dot2c_f32_bf16 v161, s41, v39
  v_dot2c_f32_bf16 v163, v39, v39
  s_waitcnt lgkmcnt(1)
  v_dot2c_f32_bf16 v156, s41, v40
  v_dot2c_f32_bf16 v158, v40, v40
  v_dot2c_f32_bf16 v157, s41, v41
  v_dot2c_f32_bf16 v159, v41, v41
  v_dot2c_f32_bf16 v156, s41, v42
  v_dot2c_f32_bf16 v158, v42, v42
  v_dot2c_f32_bf16 v157, s41, v43
  v_dot2c_f32_bf16 v159, v43, v43
  s_waitcnt lgkmcnt(0)
  v_dot2c_f32_bf16 v160, s41, v44
  v_dot2c_f32_bf16 v162, v44, v44
  v_dot2c_f32_bf16 v161, s41, v45
  v_dot2c_f32_bf16 v163, v45, v45
  v_dot2c_f32_bf16 v160, s41, v46
  v_dot2c_f32_bf16 v162, v46, v46
  v_dot2c_f32_bf16 v161, s41, v47
  v_dot2c_f32_bf16 v163, v47, v47
  s_nop 2
  v_add_f32 v156, v156, v157
  v_add_f32 v158, v158, v159
  v_add_f32 v160, v160, v161
  v_add_f32 v162, v162, v163
  s_nop 0
  v_mov_b32 v157, v156
  v_mov_b32 v159, v158
  v_mov_b32 v161, v160
  v_mov_b32 v163, v162
  s_nop 1
  v_permlane32_swap_b32 v156, v157
  v_permlane32_swap_b32 v158, v159
  v_permlane32_swap_b32 v160, v161
  v_permlane32_swap_b32 v162, v163
  s_nop 1
  v_and_b32 v12, 31, v0
  v_lshlrev_b32 v12, 2, v12
  v_add_u32 v12, 162816, v12
  v_add_f32 v156, v156, v157
  v_add_f32 v158, v158, v159
  v_mul_f32 v156, 989855744, v156
  v_mul_f32 v158, 989855744, v158
  v_fma_f32 v158, -v156, v156, v158
  v_max_f32 v158, 0, v158
  v_add_f32 v158, 925353388, v158
  v_rsq_f32 v158, v158
  s_nop 0
  v_mul_f32 v156, v156, v158
  v_sub_f32 v156, 0, v156
  ds_write_b32 v12, v158 offset:0
  ds_write_b32 v12, v156 offset:512
  v_add_f32 v160, v160, v161
  v_add_f32 v162, v162, v163
  v_mul_f32 v160, 989855744, v160
  v_mul_f32 v162, 989855744, v162
  v_fma_f32 v162, -v160, v160, v162
  v_max_f32 v162, 0, v162
  v_add_f32 v162, 925353388, v162
  v_rsq_f32 v162, v162
  s_nop 0
  v_mul_f32 v160, v160, v162
  v_sub_f32 v160, 0, v160
  ds_write_b32 v12, v162 offset:128
  ds_write_b32 v12, v160 offset:640
  s_waitcnt lgkmcnt(0)
  s_barrier
  s_barrier
  s_branch L_s2_idle
L_role_ffn:
  s_cmp_lg_u32 s3, 9
  s_cbranch_scc1 L_nopf
  s_getpc_b64 s[46:47]
L_pc:
  s_sub_u32 s46, s46, L_pc-recurrent_scan__mha_block__dense_activation_squared_relu__prompt_kernel
  s_subb_u32 s47, s47, 0
  s_lshr_b32 s48, s2, 3
  v_lshlrev_b32 v12, 4, v0
  s_cmp_ge_u32 s48, (L_code_end-recurrent_scan__mha_block__dense_activation_squared_relu__prompt_kernel+1023)/1024
  s_cbranch_scc1 L_nopf
  s_lshl_b32 s49, s48, 10
  v_add_u32 v13, s49, v12
  global_load_dwordx4 v[160:163], v13, s[46:47]
  s_add_u32 s48, s48, 32
  s_cmp_ge_u32 s48, (L_code_end-recurrent_scan__mha_block__dense_activation_squared_relu__prompt_kernel+1023)/1024
  s_cbranch_scc1 L_nopf
  s_lshl_b32 s49, s48, 10
  v_add_u32 v13, s49, v12
  global_load_dwordx4 v[164:167], v13, s[46:47]
  s_add_u32 s48, s48, 32
L_nopf:
  s_waitcnt lgkmcnt(0)
  s_mov_b32 s28, s24
  s_and_b32 s29, s25, 0xffff
  s_mov_b32 s30, 17104896
  s_mov_b32 s31, 0x20000
  s_sub_u32 s50, s3, 8
  s_lshl_b32 s44, s50, 13
  s_add_u32 s44, s44, 131072
  v_lshrrev_b32 v12, 2, v0
  s_mov_b32 s47, 3584
  v_mul_lo_u32 v12, v12, s47
  v_and_b32 v13, 3, v0
  v_lshl_add_u32 v9, v13, 4, v12
  s_lshl_b32 s51, s27, 2
  s_add_u32 s51, s51, s50
  s_lshl_b32 s42, s51, 6
  s_mov_b32 s43, 57344
  s_sub_u32 s42, s42, s43
  s_mov_b32 s32, s12
  s_and_b32 s33, s13, 0xffff
  s_mov_b32 s34, 1835008
  s_mov_b32 s35, 0x20000
  s_mov_b32 s36, s14
  s_and_b32 s37, s15, 0xffff
  s_mov_b32 s38, 3584
  s_mov_b32 s39, 0x20000
  v_lshrrev_b32 v12, 5, v0
  v_lshlrev_b32 v12, 3, v12
  s_lshl_b32 s52, s51, 6
  buffer_load_dwordx2 v[144:145], v12, s[36:39], s52 offen offset:0
  buffer_load_dwordx2 v[146:147], v12, s[36:39], s52 offen offset:16
  buffer_load_dwordx2 v[148:149], v12, s[36:39], s52 offen offset:32
  buffer_load_dwordx2 v[150:151], v12, s[36:39], s52 offen offset:48
  v_and_b32 v10, 31, v0
  v_lshrrev_b32 v11, 5, v0
  v_bfe_u32 v12, v0, 1, 3
  v_xor_b32 v12, v11, v12
  v_lshlrev_b32 v12, 4, v12
  v_lshl_or_b32 v4, v10, 7, v12
  v_xor_b32 v5, 32, v4
  v_xor_b32 v6, 64, v4
  v_xor_b32 v7, 96, v4
  v_bfe_u32 v12, v0, 2, 2
  v_lshl_add_u32 v12, v11, 3, v12
  v_lshlrev_b32 v12, 6, v12
  v_bfe_u32 v13, v0, 4, 1
  v_lshl_add_u32 v12, v13, 5, v12
  v_and_b32 v13, 3, v0
  v_lshl_add_u32 v8, v13, 3, v12
  v_add_u32 v8, s44, v8
  v_mov_b32 v64, 0
  v_mov_b32 v65, 0
  v_mov_b32 v66, 0
  v_mov_b32 v67, 0
  v_mov_b32 v68, 0
  v_mov_b32 v69, 0
  v_mov_b32 v70, 0
  v_mov_b32 v71, 0
  v_mov_b32 v72, 0
  v_mov_b32 v73, 0
  v_mov_b32 v74, 0
  v_mov_b32 v75, 0
  v_mov_b32 v76, 0
  v_mov_b32 v77, 0
  v_mov_b32 v78, 0
  v_mov_b32 v79, 0
  v_mov_b32 v80, 0
  v_mov_b32 v81, 0
  v_mov_b32 v82, 0
  v_mov_b32 v83, 0
  v_mov_b32 v84, 0
  v_mov_b32 v85, 0
  v_mov_b32 v86, 0
  v_mov_b32 v87, 0
  v_mov_b32 v88, 0
  v_mov_b32 v89, 0
  v_mov_b32 v90, 0
  v_mov_b32 v91, 0
  v_mov_b32 v92, 0
  v_mov_b32 v93, 0
  v_mov_b32 v94, 0
  v_mov_b32 v95, 0
  v_mov_b32 v96, 0
  v_mov_b32 v97, 0
  v_mov_b32 v98, 0
  v_mov_b32 v99, 0
  v_mov_b32 v100, 0
  v_mov_b32 v101, 0
  v_mov_b32 v102, 0
  v_mov_b32 v103, 0
  v_mov_b32 v104, 0
  v_mov_b32 v105, 0
  v_mov_b32 v106, 0
  v_mov_b32 v107, 0
  v_mov_b32 v108, 0
  v_mov_b32 v109, 0
  v_mov_b32 v110, 0
  v_mov_b32 v111, 0
  v_mov_b32 v112, 0
  v_mov_b32 v113, 0
  v_mov_b32 v114, 0
  v_mov_b32 v115, 0
  v_mov_b32 v116, 0
  v_mov_b32 v117, 0
  v_mov_b32 v118, 0
  v_mov_b32 v119, 0
  v_mov_b32 v120, 0
  v_mov_b32 v121, 0
  v_mov_b32 v122, 0
  v_mov_b32 v123, 0
  v_mov_b32 v124, 0
  v_mov_b32 v125, 0
  v_mov_b32 v126, 0
  v_mov_b32 v127, 0
  v_lshrrev_b32 v12, 4, v0
  v_xor_b32 v12, v12, v0
  v_and_b32 v12, 1, v12
  v_cmp_eq_u32 vcc, 0, v12
  v_mov_b32 v13, s41
  v_mov_b32 v56, 0
  v_mov_b32 v57, 0
  v_mov_b32 v58, 0
  v_mov_b32 v59, 0
  v_cndmask_b32 v60, 0, v13, vcc
  v_cndmask_b32 v61, 0, v13, vcc
  v_cndmask_b32 v62, 0, v13, vcc
  v_cndmask_b32 v63, 0, v13, vcc
  s_barrier
  s_cmp_eq_u32 s3, 10
  s_cbranch_scc0 L_tw_skip
  v_mov_b32 v166, 161808
  s_mov_b32 s58, 0
L_wsp_29:
  ds_read_b128 v[160:163], v166
  s_add_u32 s58, s58, 1
  s_waitcnt lgkmcnt(0)
  v_min3_u32 v167, v160, v161, v162
  v_min_u32 v167, v167, v163
  s_nop 0
  v_readfirstlane_b32 s57, v167
  s_cmp_ge_u32 s58, 0x100000
  s_cbranch_scc1 L_wok_30
  s_cmp_lt_u32 s57, 6
  s_cbranch_scc1 L_wsp_29
L_wok_30:
  s_mov_b32 s36, s12
  s_and_b32 s37, s13, 0xffff
  s_mov_b32 s38, 1835008
  s_mov_b32 s39, 0x20000
  s_bfe_u32 s46, s2, 0x30003
  s_mul_i32 s46, s46, 229376
  s_lshl_b32 s47, s27, 8
  s_add_u32 s46, s46, s47
  v_lshrrev_b32 v12, 1, v0
  v_mul_u32_u24 v12, 3584, v12
  v_and_b32 v13, 1, v0
  v_lshl_add_u32 v12, v13, 7, v12
  buffer_load_dword v164, v12, s[36:39], s46 offen
  s_add_u32 s46, s46, 114688
  buffer_load_dword v165, v12, s[36:39], s46 offen
  s_add_u32 s46, s46, 114688
L_tw_skip:
  s_cmp_lg_u32 s3, 11
  s_cbranch_scc1 L_ffn_b8
  v_and_b32 v10, 31, v0
  v_lshrrev_b32 v11, 5, v0
  v_bfe_u32 v12, v0, 1, 3
  v_xor_b32 v12, v11, v12
  v_lshlrev_b32 v12, 4, v12
  v_lshl_or_b32 v152, v10, 7, v12
  v_add_u32 v152, 8192, v152
  v_xor_b32 v153, 32, v152
  v_xor_b32 v154, 64, v152
  v_xor_b32 v155, 96, v152
  v_mov_b32 v156, 0
  v_mov_b32 v157, 0
  v_mov_b32 v158, 0
  v_mov_b32 v159, 0
  v_mov_b32 v160, 0
  v_mov_b32 v161, 0
  v_mov_b32 v162, 0
  v_mov_b32 v163, 0
  v_mov_b32 v12, 161816
  s_mov_b32 s58, 0
L_wsp_31:
  ds_read_b64 v[10:11], v12
  s_add_u32 s58, s58, 1
  s_waitcnt lgkmcnt(0)
  v_min_u32 v13, v10, v11
  s_nop 0
  v_readfirstlane_b32 s57, v13
  s_cmp_ge_u32 s58, 0x100000
  s_cbranch_scc1 L_wok_32
  s_cmp_lt_u32 s57, 1
  s_cbranch_scc1 L_wsp_31
L_wok_32:
  ds_read_b128 v[16:19], v152 offset:0
  ds_read_b128 v[20:23], v152 offset:4096
  ds_read_b128 v[24:27], v153 offset:0
  ds_read_b128 v[28:31], v153 offset:4096
  ds_read_b128 v[32:35], v154 offset:0
  ds_read_b128 v[36:39], v154 offset:4096
  ds_read_b128 v[40:43], v155 offset:0
  ds_read_b128 v[44:47], v155 offset:4096
  s_waitcnt lgkmcnt(7)
  v_dot2c_f32_bf16 v156, s41, v16
  v_dot2c_f32_bf16 v158, v16, v16
  v_dot2c_f32_bf16 v157, s41, v17
  v_dot2c_f32_bf16 v159, v17, v17
  v_dot2c_f32_bf16 v156, s41, v18
  v_dot2c_f32_bf16 v158, v18, v18
  v_dot2c_f32_bf16 v157, s41, v19
  v_dot2c_f32_bf16 v159, v19, v19
  s_waitcnt lgkmcnt(6)
  v_dot2c_f32_bf16 v160, s41, v20
  v_dot2c_f32_bf16 v162, v20, v20
  v_dot2c_f32_bf16 v161, s41, v21
  v_dot2c_f32_bf16 v163, v21, v21
  v_dot2c_f32_bf16 v160, s41, v22
  v_dot2c_f32_bf16 v162, v22, v22
  v_dot2c_f32_bf16 v161, s41, v23
  v_dot2c_f32_bf16 v163, v23, v23
  s_waitcnt lgkmcnt(5)
  v_dot2c_f32_bf16 v156, s41, v24
  v_dot2c_f32_bf16 v158, v24, v24
  v_dot2c_f32_bf16 v157, s41, v25
  v_dot2c_f32_bf16 v159, v25, v25
  v_dot2c_f32_bf16 v156, s41, v26
  v_dot2c_f32_bf16 v158, v26, v26
  v_dot2c_f32_bf16 v157, s41, v27
  v_dot2c_f32_bf16 v159, v27, v27
  s_waitcnt lgkmcnt(4)
  v_dot2c_f32_bf16 v160, s41, v28
  v_dot2c_f32_bf16 v162, v28, v28
  v_dot2c_f32_bf16 v161, s41, v29
  v_dot2c_f32_bf16 v163, v29, v29
  v_dot2c_f32_bf16 v160, s41, v30
  v_dot2c_f32_bf16 v162, v30, v30
  v_dot2c_f32_bf16 v161, s41, v31
  v_dot2c_f32_bf16 v163, v31, v31
  s_waitcnt lgkmcnt(3)
  v_dot2c_f32_bf16 v156, s41, v32
  v_dot2c_f32_bf16 v158, v32, v32
  v_dot2c_f32_bf16 v157, s41, v33
  v_dot2c_f32_bf16 v159, v33, v33
  v_dot2c_f32_bf16 v156, s41, v34
  v_dot2c_f32_bf16 v158, v34, v34
  v_dot2c_f32_bf16 v157, s41, v35
  v_dot2c_f32_bf16 v159, v35, v35
  s_waitcnt lgkmcnt(2)
  v_dot2c_f32_bf16 v160, s41, v36
  v_dot2c_f32_bf16 v162, v36, v36
  v_dot2c_f32_bf16 v161, s41, v37
  v_dot2c_f32_bf16 v163, v37, v37
  v_dot2c_f32_bf16 v160, s41, v38
  v_dot2c_f32_bf16 v162, v38, v38
  v_dot2c_f32_bf16 v161, s41, v39
  v_dot2c_f32_bf16 v163, v39, v39
  s_waitcnt lgkmcnt(1)
  v_dot2c_f32_bf16 v156, s41, v40
  v_dot2c_f32_bf16 v158, v40, v40
  v_dot2c_f32_bf16 v157, s41, v41
  v_dot2c_f32_bf16 v159, v41, v41
  v_dot2c_f32_bf16 v156, s41, v42
  v_dot2c_f32_bf16 v158, v42, v42
  v_dot2c_f32_bf16 v157, s41, v43
  v_dot2c_f32_bf16 v159, v43, v43
  s_waitcnt lgkmcnt(0)
  v_dot2c_f32_bf16 v160, s41, v44
  v_dot2c_f32_bf16 v162, v44, v44
  v_dot2c_f32_bf16 v161, s41, v45
  v_dot2c_f32_bf16 v163, v45, v45
  v_dot2c_f32_bf16 v160, s41, v46
  v_dot2c_f32_bf16 v162, v46, v46
  v_dot2c_f32_bf16 v161, s41, v47
  v_dot2c_f32_bf16 v163, v47, v47
  v_mov_b32 v12, 161816
  s_mov_b32 s58, 0
L_wsp_33:
  ds_read_b64 v[10:11], v12
  s_add_u32 s58, s58, 1
  s_waitcnt lgkmcnt(0)
  v_min_u32 v13, v10, v11
  s_nop 0
  v_readfirstlane_b32 s57, v13
  s_cmp_ge_u32 s58, 0x100000
  s_cbranch_scc1 L_wok_34
  s_cmp_lt_u32 s57, 2
  s_cbranch_scc1 L_wsp_33
L_wok_34:
  ds_read_b128 v[16:19], v152 offset:16384
  ds_read_b128 v[20:23], v152 offset:20480
  ds_read_b128 v[24:27], v153 offset:16384
  ds_read_b128 v[28:31], v153 offset:20480
  ds_read_b128 v[32:35], v154 offset:16384
  ds_read_b128 v[36:39], v154 offset:20480
  ds_read_b128 v[40:43], v155 offset:16384
  ds_read_b128 v[44:47], v155 offset:20480
  s_waitcnt lgkmcnt(7)
  v_dot2c_f32_bf16 v156, s41, v16
  v_dot2c_f32_bf16 v158, v16, v16
  v_dot2c_f32_bf16 v157, s41, v17
  v_dot2c_f32_bf16 v159, v17, v17
  v_dot2c_f32_bf16 v156, s41, v18
  v_dot2c_f32_bf16 v158, v18, v18
  v_dot2c_f32_bf16 v157, s41, v19
  v_dot2c_f32_bf16 v159, v19, v19
  s_waitcnt lgkmcnt(6)
  v_dot2c_f32_bf16 v160, s41, v20
  v_dot2c_f32_bf16 v162, v20, v20
  v_dot2c_f32_bf16 v161, s41, v21
  v_dot2c_f32_bf16 v163, v21, v21
  v_dot2c_f32_bf16 v160, s41, v22
  v_dot2c_f32_bf16 v162, v22, v22
  v_dot2c_f32_bf16 v161, s41, v23
  v_dot2c_f32_bf16 v163, v23, v23
  s_waitcnt lgkmcnt(5)
  v_dot2c_f32_bf16 v156, s41, v24
  v_dot2c_f32_bf16 v158, v24, v24
  v_dot2c_f32_bf16 v157, s41, v25
  v_dot2c_f32_bf16 v159, v25, v25
  v_dot2c_f32_bf16 v156, s41, v26
  v_dot2c_f32_bf16 v158, v26, v26
  v_dot2c_f32_bf16 v157, s41, v27
  v_dot2c_f32_bf16 v159, v27, v27
  s_waitcnt lgkmcnt(4)
  v_dot2c_f32_bf16 v160, s41, v28
  v_dot2c_f32_bf16 v162, v28, v28
  v_dot2c_f32_bf16 v161, s41, v29
  v_dot2c_f32_bf16 v163, v29, v29
  v_dot2c_f32_bf16 v160, s41, v30
  v_dot2c_f32_bf16 v162, v30, v30
  v_dot2c_f32_bf16 v161, s41, v31
  v_dot2c_f32_bf16 v163, v31, v31
  s_waitcnt lgkmcnt(3)
  v_dot2c_f32_bf16 v156, s41, v32
  v_dot2c_f32_bf16 v158, v32, v32
  v_dot2c_f32_bf16 v157, s41, v33
  v_dot2c_f32_bf16 v159, v33, v33
  v_dot2c_f32_bf16 v156, s41, v34
  v_dot2c_f32_bf16 v158, v34, v34
  v_dot2c_f32_bf16 v157, s41, v35
  v_dot2c_f32_bf16 v159, v35, v35
  s_waitcnt lgkmcnt(2)
  v_dot2c_f32_bf16 v160, s41, v36
  v_dot2c_f32_bf16 v162, v36, v36
  v_dot2c_f32_bf16 v161, s41, v37
  v_dot2c_f32_bf16 v163, v37, v37
  v_dot2c_f32_bf16 v160, s41, v38
  v_dot2c_f32_bf16 v162, v38, v38
  v_dot2c_f32_bf16 v161, s41, v39
  v_dot2c_f32_bf16 v163, v39, v39
  s_waitcnt lgkmcnt(1)
  v_dot2c_f32_bf16 v156, s41, v40
  v_dot2c_f32_bf16 v158, v40, v40
  v_dot2c_f32_bf16 v157, s41, v41
  v_dot2c_f32_bf16 v159, v41, v41
  v_dot2c_f32_bf16 v156, s41, v42
  v_dot2c_f32_bf16 v158, v42, v42
  v_dot2c_f32_bf16 v157, s41, v43
  v_dot2c_f32_bf16 v159, v43, v43
  s_waitcnt lgkmcnt(0)
  v_dot2c_f32_bf16 v160, s41, v44
  v_dot2c_f32_bf16 v162, v44, v44
  v_dot2c_f32_bf16 v161, s41, v45
  v_dot2c_f32_bf16 v163, v45, v45
  v_dot2c_f32_bf16 v160, s41, v46
  v_dot2c_f32_bf16 v162, v46, v46
  v_dot2c_f32_bf16 v161, s41, v47
  v_dot2c_f32_bf16 v163, v47, v47
  v_mov_b32 v12, 161816
  s_mov_b32 s58, 0
L_wsp_35:
  ds_read_b64 v[10:11], v12
  s_add_u32 s58, s58, 1
  s_waitcnt lgkmcnt(0)
  v_min_u32 v13, v10, v11
  s_nop 0
  v_readfirstlane_b32 s57, v13
  s_cmp_ge_u32 s58, 0x100000
  s_cbranch_scc1 L_wok_36
  s_cmp_lt_u32 s57, 3
  s_cbranch_scc1 L_wsp_35
L_wok_36:
  ds_read_b128 v[16:19], v152 offset:32768
  ds_read_b128 v[20:23], v152 offset:36864
  ds_read_b128 v[24:27], v153 offset:32768
  ds_read_b128 v[28:31], v153 offset:36864
  ds_read_b128 v[32:35], v154 offset:32768
  ds_read_b128 v[36:39], v154 offset:36864
  ds_read_b128 v[40:43], v155 offset:32768
  ds_read_b128 v[44:47], v155 offset:36864
  s_waitcnt lgkmcnt(7)
  v_dot2c_f32_bf16 v156, s41, v16
  v_dot2c_f32_bf16 v158, v16, v16
  v_dot2c_f32_bf16 v157, s41, v17
  v_dot2c_f32_bf16 v159, v17, v17
  v_dot2c_f32_bf16 v156, s41, v18
  v_dot2c_f32_bf16 v158, v18, v18
  v_dot2c_f32_bf16 v157, s41, v19
  v_dot2c_f32_bf16 v159, v19, v19
  s_waitcnt lgkmcnt(6)
  v_dot2c_f32_bf16 v160, s41, v20
  v_dot2c_f32_bf16 v162, v20, v20
  v_dot2c_f32_bf16 v161, s41, v21
  v_dot2c_f32_bf16 v163, v21, v21
  v_dot2c_f32_bf16 v160, s41, v22
  v_dot2c_f32_bf16 v162, v22, v22
  v_dot2c_f32_bf16 v161, s41, v23
  v_dot2c_f32_bf16 v163, v23, v23
  s_waitcnt lgkmcnt(5)
  v_dot2c_f32_bf16 v156, s41, v24
  v_dot2c_f32_bf16 v158, v24, v24
  v_dot2c_f32_bf16 v157, s41, v25
  v_dot2c_f32_bf16 v159, v25, v25
  v_dot2c_f32_bf16 v156, s41, v26
  v_dot2c_f32_bf16 v158, v26, v26
  v_dot2c_f32_bf16 v157, s41, v27
  v_dot2c_f32_bf16 v159, v27, v27
  s_waitcnt lgkmcnt(4)
  v_dot2c_f32_bf16 v160, s41, v28
  v_dot2c_f32_bf16 v162, v28, v28
  v_dot2c_f32_bf16 v161, s41, v29
  v_dot2c_f32_bf16 v163, v29, v29
  v_dot2c_f32_bf16 v160, s41, v30
  v_dot2c_f32_bf16 v162, v30, v30
  v_dot2c_f32_bf16 v161, s41, v31
  v_dot2c_f32_bf16 v163, v31, v31
  s_waitcnt lgkmcnt(3)
  v_dot2c_f32_bf16 v156, s41, v32
  v_dot2c_f32_bf16 v158, v32, v32
  v_dot2c_f32_bf16 v157, s41, v33
  v_dot2c_f32_bf16 v159, v33, v33
  v_dot2c_f32_bf16 v156, s41, v34
  v_dot2c_f32_bf16 v158, v34, v34
  v_dot2c_f32_bf16 v157, s41, v35
  v_dot2c_f32_bf16 v159, v35, v35
  s_waitcnt lgkmcnt(2)
  v_dot2c_f32_bf16 v160, s41, v36
  v_dot2c_f32_bf16 v162, v36, v36
  v_dot2c_f32_bf16 v161, s41, v37
  v_dot2c_f32_bf16 v163, v37, v37
  v_dot2c_f32_bf16 v160, s41, v38
  v_dot2c_f32_bf16 v162, v38, v38
  v_dot2c_f32_bf16 v161, s41, v39
  v_dot2c_f32_bf16 v163, v39, v39
  s_waitcnt lgkmcnt(1)
  v_dot2c_f32_bf16 v156, s41, v40
  v_dot2c_f32_bf16 v158, v40, v40
  v_dot2c_f32_bf16 v157, s41, v41
  v_dot2c_f32_bf16 v159, v41, v41
  v_dot2c_f32_bf16 v156, s41, v42
  v_dot2c_f32_bf16 v158, v42, v42
  v_dot2c_f32_bf16 v157, s41, v43
  v_dot2c_f32_bf16 v159, v43, v43
  s_waitcnt lgkmcnt(0)
  v_dot2c_f32_bf16 v160, s41, v44
  v_dot2c_f32_bf16 v162, v44, v44
  v_dot2c_f32_bf16 v161, s41, v45
  v_dot2c_f32_bf16 v163, v45, v45
  v_dot2c_f32_bf16 v160, s41, v46
  v_dot2c_f32_bf16 v162, v46, v46
  v_dot2c_f32_bf16 v161, s41, v47
  v_dot2c_f32_bf16 v163, v47, v47
  v_mov_b32 v12, 161816
  s_mov_b32 s58, 0
L_wsp_37:
  ds_read_b64 v[10:11], v12
  s_add_u32 s58, s58, 1
  s_waitcnt lgkmcnt(0)
  v_min_u32 v13, v10, v11
  s_nop 0
  v_readfirstlane_b32 s57, v13
  s_cmp_ge_u32 s58, 0x100000
  s_cbranch_scc1 L_wok_38
  s_cmp_lt_u32 s57, 4
  s_cbranch_scc1 L_wsp_37
L_wok_38:
  ds_read_b128 v[16:19], v152 offset:49152
  ds_read_b128 v[20:23], v152 offset:53248
  ds_read_b128 v[24:27], v153 offset:49152
  ds_read_b128 v[28:31], v153 offset:53248
  ds_read_b128 v[32:35], v154 offset:49152
  ds_read_b128 v[36:39], v154 offset:53248
  ds_read_b128 v[40:43], v155 offset:49152
  ds_read_b128 v[44:47], v155 offset:53248
  s_waitcnt lgkmcnt(7)
  v_dot2c_f32_bf16 v156, s41, v16
  v_dot2c_f32_bf16 v158, v16, v16
  v_dot2c_f32_bf16 v157, s41, v17
  v_dot2c_f32_bf16 v159, v17, v17
  v_dot2c_f32_bf16 v156, s41, v18
  v_dot2c_f32_bf16 v158, v18, v18
  v_dot2c_f32_bf16 v157, s41, v19
  v_dot2c_f32_bf16 v159, v19, v19
  s_waitcnt lgkmcnt(6)
  v_dot2c_f32_bf16 v160, s41, v20
  v_dot2c_f32_bf16 v162, v20, v20
  v_dot2c_f32_bf16 v161, s41, v21
  v_dot2c_f32_bf16 v163, v21, v21
  v_dot2c_f32_bf16 v160, s41, v22
  v_dot2c_f32_bf16 v162, v22, v22
  v_dot2c_f32_bf16 v161, s41, v23
  v_dot2c_f32_bf16 v163, v23, v23
  s_waitcnt lgkmcnt(5)
  v_dot2c_f32_bf16 v156, s41, v24
  v_dot2c_f32_bf16 v158, v24, v24
  v_dot2c_f32_bf16 v157, s41, v25
  v_dot2c_f32_bf16 v159, v25, v25
  v_dot2c_f32_bf16 v156, s41, v26
  v_dot2c_f32_bf16 v158, v26, v26
  v_dot2c_f32_bf16 v157, s41, v27
  v_dot2c_f32_bf16 v159, v27, v27
  s_waitcnt lgkmcnt(4)
  v_dot2c_f32_bf16 v160, s41, v28
  v_dot2c_f32_bf16 v162, v28, v28
  v_dot2c_f32_bf16 v161, s41, v29
  v_dot2c_f32_bf16 v163, v29, v29
  v_dot2c_f32_bf16 v160, s41, v30
  v_dot2c_f32_bf16 v162, v30, v30
  v_dot2c_f32_bf16 v161, s41, v31
  v_dot2c_f32_bf16 v163, v31, v31
  s_waitcnt lgkmcnt(3)
  v_dot2c_f32_bf16 v156, s41, v32
  v_dot2c_f32_bf16 v158, v32, v32
  v_dot2c_f32_bf16 v157, s41, v33
  v_dot2c_f32_bf16 v159, v33, v33
  v_dot2c_f32_bf16 v156, s41, v34
  v_dot2c_f32_bf16 v158, v34, v34
  v_dot2c_f32_bf16 v157, s41, v35
  v_dot2c_f32_bf16 v159, v35, v35
  s_waitcnt lgkmcnt(2)
  v_dot2c_f32_bf16 v160, s41, v36
  v_dot2c_f32_bf16 v162, v36, v36
  v_dot2c_f32_bf16 v161, s41, v37
  v_dot2c_f32_bf16 v163, v37, v37
  v_dot2c_f32_bf16 v160, s41, v38
  v_dot2c_f32_bf16 v162, v38, v38
  v_dot2c_f32_bf16 v161, s41, v39
  v_dot2c_f32_bf16 v163, v39, v39
  s_waitcnt lgkmcnt(1)
  v_dot2c_f32_bf16 v156, s41, v40
  v_dot2c_f32_bf16 v158, v40, v40
  v_dot2c_f32_bf16 v157, s41, v41
  v_dot2c_f32_bf16 v159, v41, v41
  v_dot2c_f32_bf16 v156, s41, v42
  v_dot2c_f32_bf16 v158, v42, v42
  v_dot2c_f32_bf16 v157, s41, v43
  v_dot2c_f32_bf16 v159, v43, v43
  s_waitcnt lgkmcnt(0)
  v_dot2c_f32_bf16 v160, s41, v44
  v_dot2c_f32_bf16 v162, v44, v44
  v_dot2c_f32_bf16 v161, s41, v45
  v_dot2c_f32_bf16 v163, v45, v45
  v_dot2c_f32_bf16 v160, s41, v46
  v_dot2c_f32_bf16 v162, v46, v46
  v_dot2c_f32_bf16 v161, s41, v47
  v_dot2c_f32_bf16 v163, v47, v47
  v_mov_b32 v12, 161816
  s_mov_b32 s58, 0
L_wsp_39:
  ds_read_b64 v[10:11], v12
  s_add_u32 s58, s58, 1
  s_waitcnt lgkmcnt(0)
  v_min_u32 v13, v10, v11
  s_nop 0
  v_readfirstlane_b32 s57, v13
  s_cmp_ge_u32 s58, 0x100000
  s_cbranch_scc1 L_wok_40
  s_cmp_lt_u32 s57, 5
  s_cbranch_scc1 L_wsp_39
L_wok_40:
  v_add_u32 v152, 0x10000, v152
  v_add_u32 v153, 0x10000, v153
  v_add_u32 v154, 0x10000, v154
  v_add_u32 v155, 0x10000, v155
  ds_read_b128 v[16:19], v152 offset:0
  ds_read_b128 v[20:23], v152 offset:4096
  ds_read_b128 v[24:27], v153 offset:0
  ds_read_b128 v[28:31], v153 offset:4096
  ds_read_b128 v[32:35], v154 offset:0
  ds_read_b128 v[36:39], v154 offset:4096
  ds_read_b128 v[40:43], v155 offset:0
  ds_read_b128 v[44:47], v155 offset:4096
  s_waitcnt lgkmcnt(7)
  v_dot2c_f32_bf16 v156, s41, v16
  v_dot2c_f32_bf16 v158, v16, v16
  v_dot2c_f32_bf16 v157, s41, v17
  v_dot2c_f32_bf16 v159, v17, v17
  v_dot2c_f32_bf16 v156, s41, v18
  v_dot2c_f32_bf16 v158, v18, v18
  v_dot2c_f32_bf16 v157, s41, v19
  v_dot2c_f32_bf16 v159, v19, v19
  s_waitcnt lgkmcnt(6)
  v_dot2c_f32_bf16 v160, s41, v20
  v_dot2c_f32_bf16 v162, v20, v20
  v_dot2c_f32_bf16 v161, s41, v21
  v_dot2c_f32_bf16 v163, v21, v21
  v_dot2c_f32_bf16 v160, s41, v22
  v_dot2c_f32_bf16 v162, v22, v22
  v_dot2c_f32_bf16 v161, s41, v23
  v_dot2c_f32_bf16 v163, v23, v23
  s_waitcnt lgkmcnt(5)
  v_dot2c_f32_bf16 v156, s41, v24
  v_dot2c_f32_bf16 v158, v24, v24
  v_dot2c_f32_bf16 v157, s41, v25
  v_dot2c_f32_bf16 v159, v25, v25
  v_dot2c_f32_bf16 v156, s41, v26
  v_dot2c_f32_bf16 v158, v26, v26
  v_dot2c_f32_bf16 v157, s41, v27
  v_dot2c_f32_bf16 v159, v27, v27
  s_waitcnt lgkmcnt(4)
  v_dot2c_f32_bf16 v160, s41, v28
  v_dot2c_f32_bf16 v162, v28, v28
  v_dot2c_f32_bf16 v161, s41, v29
  v_dot2c_f32_bf16 v163, v29, v29
  v_dot2c_f32_bf16 v160, s41, v30
  v_dot2c_f32_bf16 v162, v30, v30
  v_dot2c_f32_bf16 v161, s41, v31
  v_dot2c_f32_bf16 v163, v31, v31
  s_waitcnt lgkmcnt(3)
  v_dot2c_f32_bf16 v156, s41, v32
  v_dot2c_f32_bf16 v158, v32, v32
  v_dot2c_f32_bf16 v157, s41, v33
  v_dot2c_f32_bf16 v159, v33, v33
  v_dot2c_f32_bf16 v156, s41, v34
  v_dot2c_f32_bf16 v158, v34, v34
  v_dot2c_f32_bf16 v157, s41, v35
  v_dot2c_f32_bf16 v159, v35, v35
  s_waitcnt lgkmcnt(2)
  v_dot2c_f32_bf16 v160, s41, v36
  v_dot2c_f32_bf16 v162, v36, v36
  v_dot2c_f32_bf16 v161, s41, v37
  v_dot2c_f32_bf16 v163, v37, v37
  v_dot2c_f32_bf16 v160, s41, v38
  v_dot2c_f32_bf16 v162, v38, v38
  v_dot2c_f32_bf16 v161, s41, v39
  v_dot2c_f32_bf16 v163, v39, v39
  s_waitcnt lgkmcnt(1)
  v_dot2c_f32_bf16 v156, s41, v40
  v_dot2c_f32_bf16 v158, v40, v40
  v_dot2c_f32_bf16 v157, s41, v41
  v_dot2c_f32_bf16 v159, v41, v41
  v_dot2c_f32_bf16 v156, s41, v42
  v_dot2c_f32_bf16 v158, v42, v42
  v_dot2c_f32_bf16 v157, s41, v43
  v_dot2c_f32_bf16 v159, v43, v43
  s_waitcnt lgkmcnt(0)
  v_dot2c_f32_bf16 v160, s41, v44
  v_dot2c_f32_bf16 v162, v44, v44
  v_dot2c_f32_bf16 v161, s41, v45
  v_dot2c_f32_bf16 v163, v45, v45
  v_dot2c_f32_bf16 v160, s41, v46
  v_dot2c_f32_bf16 v162, v46, v46
  v_dot2c_f32_bf16 v161, s41, v47
  v_dot2c_f32_bf16 v163, v47, v47
  v_mov_b32 v12, 161816
  s_mov_b32 s58, 0
L_wsp_41:
  ds_read_b64 v[10:11], v12
  s_add_u32 s58, s58, 1
  s_waitcnt lgkmcnt(0)
  v_min_u32 v13, v10, v11
  s_nop 0
  v_readfirstlane_b32 s57, v13
  s_cmp_ge_u32 s58, 0x100000
  s_cbranch_scc1 L_wok_42
  s_cmp_lt_u32 s57, 6
  s_cbranch_scc1 L_wsp_41
L_wok_42:
  ds_read_b128 v[16:19], v152 offset:16384
  ds_read_b128 v[20:23], v152 offset:20480
  ds_read_b128 v[24:27], v153 offset:16384
  ds_read_b128 v[28:31], v153 offset:20480
  ds_read_b128 v[32:35], v154 offset:16384
  ds_read_b128 v[36:39], v154 offset:20480
  ds_read_b128 v[40:43], v155 offset:16384
  ds_read_b128 v[44:47], v155 offset:20480
  s_waitcnt lgkmcnt(7)
  v_dot2c_f32_bf16 v156, s41, v16
  v_dot2c_f32_bf16 v158, v16, v16
  v_dot2c_f32_bf16 v157, s41, v17
  v_dot2c_f32_bf16 v159, v17, v17
  v_dot2c_f32_bf16 v156, s41, v18
  v_dot2c_f32_bf16 v158, v18, v18
  v_dot2c_f32_bf16 v157, s41, v19
  v_dot2c_f32_bf16 v159, v19, v19
  s_waitcnt lgkmcnt(6)
  v_dot2c_f32_bf16 v160, s41, v20
  v_dot2c_f32_bf16 v162, v20, v20
  v_dot2c_f32_bf16 v161, s41, v21
  v_dot2c_f32_bf16 v163, v21, v21
  v_dot2c_f32_bf16 v160, s41, v22
  v_dot2c_f32_bf16 v162, v22, v22
  v_dot2c_f32_bf16 v161, s41, v23
  v_dot2c_f32_bf16 v163, v23, v23
  s_waitcnt lgkmcnt(5)
  v_dot2c_f32_bf16 v156, s41, v24
  v_dot2c_f32_bf16 v158, v24, v24
  v_dot2c_f32_bf16 v157, s41, v25
  v_dot2c_f32_bf16 v159, v25, v25
  v_dot2c_f32_bf16 v156, s41, v26
  v_dot2c_f32_bf16 v158, v26, v26
  v_dot2c_f32_bf16 v157, s41, v27
  v_dot2c_f32_bf16 v159, v27, v27
  s_waitcnt lgkmcnt(4)
  v_dot2c_f32_bf16 v160, s41, v28
  v_dot2c_f32_bf16 v162, v28, v28
  v_dot2c_f32_bf16 v161, s41, v29
  v_dot2c_f32_bf16 v163, v29, v29
  v_dot2c_f32_bf16 v160, s41, v30
  v_dot2c_f32_bf16 v162, v30, v30
  v_dot2c_f32_bf16 v161, s41, v31
  v_dot2c_f32_bf16 v163, v31, v31
  s_waitcnt lgkmcnt(3)
  v_dot2c_f32_bf16 v156, s41, v32
  v_dot2c_f32_bf16 v158, v32, v32
  v_dot2c_f32_bf16 v157, s41, v33
  v_dot2c_f32_bf16 v159, v33, v33
  v_dot2c_f32_bf16 v156, s41, v34
  v_dot2c_f32_bf16 v158, v34, v34
  v_dot2c_f32_bf16 v157, s41, v35
  v_dot2c_f32_bf16 v159, v35, v35
  s_waitcnt lgkmcnt(2)
  v_dot2c_f32_bf16 v160, s41, v36
  v_dot2c_f32_bf16 v162, v36, v36
  v_dot2c_f32_bf16 v161, s41, v37
  v_dot2c_f32_bf16 v163, v37, v37
  v_dot2c_f32_bf16 v160, s41, v38
  v_dot2c_f32_bf16 v162, v38, v38
  v_dot2c_f32_bf16 v161, s41, v39
  v_dot2c_f32_bf16 v163, v39, v39
  s_waitcnt lgkmcnt(1)
  v_dot2c_f32_bf16 v156, s41, v40
  v_dot2c_f32_bf16 v158, v40, v40
  v_dot2c_f32_bf16 v157, s41, v41
  v_dot2c_f32_bf16 v159, v41, v41
  v_dot2c_f32_bf16 v156, s41, v42
  v_dot2c_f32_bf16 v158, v42, v42
  v_dot2c_f32_bf16 v157, s41, v43
  v_dot2c_f32_bf16 v159, v43, v43
  s_waitcnt lgkmcnt(0)
  v_dot2c_f32_bf16 v160, s41, v44
  v_dot2c_f32_bf16 v162, v44, v44
  v_dot2c_f32_bf16 v161, s41, v45
  v_dot2c_f32_bf16 v163, v45, v45
  v_dot2c_f32_bf16 v160, s41, v46
  v_dot2c_f32_bf16 v162, v46, v46
  v_dot2c_f32_bf16 v161, s41, v47
  v_dot2c_f32_bf16 v163, v47, v47
  v_mov_b32 v12, 161816
  s_mov_b32 s58, 0
L_wsp_43:
  ds_read_b64 v[10:11], v12
  s_add_u32 s58, s58, 1
  s_waitcnt lgkmcnt(0)
  v_min_u32 v13, v10, v11
  s_nop 0
  v_readfirstlane_b32 s57, v13
  s_cmp_ge_u32 s58, 0x100000
  s_cbranch_scc1 L_wok_44
  s_cmp_lt_u32 s57, 7
  s_cbranch_scc1 L_wsp_43
L_wok_44:
  ds_read_b128 v[16:19], v152 offset:32768
  ds_read_b128 v[20:23], v152 offset:36864
  ds_read_b128 v[24:27], v153 offset:32768
  ds_read_b128 v[28:31], v153 offset:36864
  ds_read_b128 v[32:35], v154 offset:32768
  ds_read_b128 v[36:39], v154 offset:36864
  ds_read_b128 v[40:43], v155 offset:32768
  ds_read_b128 v[44:47], v155 offset:36864
  s_waitcnt lgkmcnt(7)
  v_dot2c_f32_bf16 v156, s41, v16
  v_dot2c_f32_bf16 v158, v16, v16
  v_dot2c_f32_bf16 v157, s41, v17
  v_dot2c_f32_bf16 v159, v17, v17
  v_dot2c_f32_bf16 v156, s41, v18
  v_dot2c_f32_bf16 v158, v18, v18
  v_dot2c_f32_bf16 v157, s41, v19
  v_dot2c_f32_bf16 v159, v19, v19
  s_waitcnt lgkmcnt(6)
  v_dot2c_f32_bf16 v160, s41, v20
  v_dot2c_f32_bf16 v162, v20, v20
  v_dot2c_f32_bf16 v161, s41, v21
  v_dot2c_f32_bf16 v163, v21, v21
  v_dot2c_f32_bf16 v160, s41, v22
  v_dot2c_f32_bf16 v162, v22, v22
  v_dot2c_f32_bf16 v161, s41, v23
  v_dot2c_f32_bf16 v163, v23, v23
  s_waitcnt lgkmcnt(5)
  v_dot2c_f32_bf16 v156, s41, v24
  v_dot2c_f32_bf16 v158, v24, v24
  v_dot2c_f32_bf16 v157, s41, v25
  v_dot2c_f32_bf16 v159, v25, v25
  v_dot2c_f32_bf16 v156, s41, v26
  v_dot2c_f32_bf16 v158, v26, v26
  v_dot2c_f32_bf16 v157, s41, v27
  v_dot2c_f32_bf16 v159, v27, v27
  s_waitcnt lgkmcnt(4)
  v_dot2c_f32_bf16 v160, s41, v28
  v_dot2c_f32_bf16 v162, v28, v28
  v_dot2c_f32_bf16 v161, s41, v29
  v_dot2c_f32_bf16 v163, v29, v29
  v_dot2c_f32_bf16 v160, s41, v30
  v_dot2c_f32_bf16 v162, v30, v30
  v_dot2c_f32_bf16 v161, s41, v31
  v_dot2c_f32_bf16 v163, v31, v31
  s_waitcnt lgkmcnt(3)
  v_dot2c_f32_bf16 v156, s41, v32
  v_dot2c_f32_bf16 v158, v32, v32
  v_dot2c_f32_bf16 v157, s41, v33
  v_dot2c_f32_bf16 v159, v33, v33
  v_dot2c_f32_bf16 v156, s41, v34
  v_dot2c_f32_bf16 v158, v34, v34
  v_dot2c_f32_bf16 v157, s41, v35
  v_dot2c_f32_bf16 v159, v35, v35
  s_waitcnt lgkmcnt(2)
  v_dot2c_f32_bf16 v160, s41, v36
  v_dot2c_f32_bf16 v162, v36, v36
  v_dot2c_f32_bf16 v161, s41, v37
  v_dot2c_f32_bf16 v163, v37, v37
  v_dot2c_f32_bf16 v160, s41, v38
  v_dot2c_f32_bf16 v162, v38, v38
  v_dot2c_f32_bf16 v161, s41, v39
  v_dot2c_f32_bf16 v163, v39, v39
  s_waitcnt lgkmcnt(1)
  v_dot2c_f32_bf16 v156, s41, v40
  v_dot2c_f32_bf16 v158, v40, v40
  v_dot2c_f32_bf16 v157, s41, v41
  v_dot2c_f32_bf16 v159, v41, v41
  v_dot2c_f32_bf16 v156, s41, v42
  v_dot2c_f32_bf16 v158, v42, v42
  v_dot2c_f32_bf16 v157, s41, v43
  v_dot2c_f32_bf16 v159, v43, v43
  s_waitcnt lgkmcnt(0)
  v_dot2c_f32_bf16 v160, s41, v44
  v_dot2c_f32_bf16 v162, v44, v44
  v_dot2c_f32_bf16 v161, s41, v45
  v_dot2c_f32_bf16 v163, v45, v45
  v_dot2c_f32_bf16 v160, s41, v46
  v_dot2c_f32_bf16 v162, v46, v46
  v_dot2c_f32_bf16 v161, s41, v47
  v_dot2c_f32_bf16 v163, v47, v47
  v_mov_b32 v12, 161816
  s_mov_b32 s58, 0
L_wsp_45:
  ds_read_b64 v[10:11], v12
  s_add_u32 s58, s58, 1
  s_waitcnt lgkmcnt(0)
  v_min_u32 v13, v10, v11
  s_nop 0
  v_readfirstlane_b32 s57, v13
  s_cmp_ge_u32 s58, 0x100000
  s_cbranch_scc1 L_wok_46
  s_cmp_lt_u32 s57, 8
  s_cbranch_scc1 L_wsp_45
L_wok_46:
  ds_read_b128 v[16:19], v152 offset:49152
  ds_read_b128 v[20:23], v152 offset:53248
  ds_read_b128 v[24:27], v153 offset:49152
  ds_read_b128 v[28:31], v153 offset:53248
  ds_read_b128 v[32:35], v154 offset:49152
  ds_read_b128 v[36:39], v154 offset:53248
  ds_read_b128 v[40:43], v155 offset:49152
  ds_read_b128 v[44:47], v155 offset:53248
  s_waitcnt lgkmcnt(7)
  v_dot2c_f32_bf16 v156, s41, v16
  v_dot2c_f32_bf16 v158, v16, v16
  v_dot2c_f32_bf16 v157, s41, v17
  v_dot2c_f32_bf16 v159, v17, v17
  v_dot2c_f32_bf16 v156, s41, v18
  v_dot2c_f32_bf16 v158, v18, v18
  v_dot2c_f32_bf16 v157, s41, v19
  v_dot2c_f32_bf16 v159, v19, v19
  s_waitcnt lgkmcnt(6)
  v_dot2c_f32_bf16 v160, s41, v20
  v_dot2c_f32_bf16 v162, v20, v20
  v_dot2c_f32_bf16 v161, s41, v21
  v_dot2c_f32_bf16 v163, v21, v21
  v_dot2c_f32_bf16 v160, s41, v22
  v_dot2c_f32_bf16 v162, v22, v22
  v_dot2c_f32_bf16 v161, s41, v23
  v_dot2c_f32_bf16 v163, v23, v23
  s_waitcnt lgkmcnt(5)
  v_dot2c_f32_bf16 v156, s41, v24
  v_dot2c_f32_bf16 v158, v24, v24
  v_dot2c_f32_bf16 v157, s41, v25
  v_dot2c_f32_bf16 v159, v25, v25
  v_dot2c_f32_bf16 v156, s41, v26
  v_dot2c_f32_bf16 v158, v26, v26
  v_dot2c_f32_bf16 v157, s41, v27
  v_dot2c_f32_bf16 v159, v27, v27
  s_waitcnt lgkmcnt(4)
  v_dot2c_f32_bf16 v160, s41, v28
  v_dot2c_f32_bf16 v162, v28, v28
  v_dot2c_f32_bf16 v161, s41, v29
  v_dot2c_f32_bf16 v163, v29, v29
  v_dot2c_f32_bf16 v160, s41, v30
  v_dot2c_f32_bf16 v162, v30, v30
  v_dot2c_f32_bf16 v161, s41, v31
  v_dot2c_f32_bf16 v163, v31, v31
  s_waitcnt lgkmcnt(3)
  v_dot2c_f32_bf16 v156, s41, v32
  v_dot2c_f32_bf16 v158, v32, v32
  v_dot2c_f32_bf16 v157, s41, v33
  v_dot2c_f32_bf16 v159, v33, v33
  v_dot2c_f32_bf16 v156, s41, v34
  v_dot2c_f32_bf16 v158, v34, v34
  v_dot2c_f32_bf16 v157, s41, v35
  v_dot2c_f32_bf16 v159, v35, v35
  s_waitcnt lgkmcnt(2)
  v_dot2c_f32_bf16 v160, s41, v36
  v_dot2c_f32_bf16 v162, v36, v36
  v_dot2c_f32_bf16 v161, s41, v37
  v_dot2c_f32_bf16 v163, v37, v37
  v_dot2c_f32_bf16 v160, s41, v38
  v_dot2c_f32_bf16 v162, v38, v38
  v_dot2c_f32_bf16 v161, s41, v39
  v_dot2c_f32_bf16 v163, v39, v39
  s_waitcnt lgkmcnt(1)
  v_dot2c_f32_bf16 v156, s41, v40
  v_dot2c_f32_bf16 v158, v40, v40
  v_dot2c_f32_bf16 v157, s41, v41
  v_dot2c_f32_bf16 v159, v41, v41
  v_dot2c_f32_bf16 v156, s41, v42
  v_dot2c_f32_bf16 v158, v42, v42
  v_dot2c_f32_bf16 v157, s41, v43
  v_dot2c_f32_bf16 v159, v43, v43
  s_waitcnt lgkmcnt(0)
  v_dot2c_f32_bf16 v160, s41, v44
  v_dot2c_f32_bf16 v162, v44, v44
  v_dot2c_f32_bf16 v161, s41, v45
  v_dot2c_f32_bf16 v163, v45, v45
  v_dot2c_f32_bf16 v160, s41, v46
  v_dot2c_f32_bf16 v162, v46, v46
  v_dot2c_f32_bf16 v161, s41, v47
  v_dot2c_f32_bf16 v163, v47, v47
  s_nop 2
  v_add_f32 v156, v156, v157
  v_add_f32 v158, v158, v159
  v_add_f32 v160, v160, v161
  v_add_f32 v162, v162, v163
  s_nop 0
  v_mov_b32 v157, v156
  v_mov_b32 v159, v158
  v_mov_b32 v161, v160
  v_mov_b32 v163, v162
  s_nop 1
  v_permlane32_swap_b32 v156, v157
  v_permlane32_swap_b32 v158, v159
  v_permlane32_swap_b32 v160, v161
  v_permlane32_swap_b32 v162, v163
  s_nop 1
  v_and_b32 v12, 31, v0
  v_lshlrev_b32 v12, 2, v12
  v_add_u32 v12, 163072, v12
  v_add_f32 v156, v156, v157
  v_add_f32 v158, v158, v159
  v_mul_f32 v156, 989855744, v156
  v_mul_f32 v158, 989855744, v158
  v_fma_f32 v158, -v156, v156, v158
  v_max_f32 v158, 0, v158
  v_add_f32 v158, 925353388, v158
  v_rsq_f32 v158, v158
  s_nop 0
  v_mul_f32 v156, v156, v158
  v_sub_f32 v156, 0, v156
  ds_write_b32 v12, v158 offset:0
  ds_write_b32 v12, v156 offset:512
  v_add_f32 v160, v160, v161
  v_add_f32 v162, v162, v163
  v_mul_f32 v160, 989855744, v160
  v_mul_f32 v162, 989855744, v162
  v_fma_f32 v162, -v160, v160, v162
  v_max_f32 v162, 0, v162
  v_add_f32 v162, 925353388, v162
  v_rsq_f32 v162, v162
  s_nop 0
  v_mul_f32 v160, v160, v162
  v_sub_f32 v160, 0, v160
  ds_write_b32 v12, v162 offset:128
  ds_write_b32 v12, v160 offset:640
  s_waitcnt lgkmcnt(0)
L_ffn_b8:
  s_barrier
  s_cmp_ge_u32 s27, 14
  s_cbranch_scc1 L_ffn_skip
  s_add_u32 m0, s44, 0
  s_add_u32 s42, s42, s43
  buffer_load_dwordx4 v9, s[32:35], s42 offen lds
  s_add_u32 m0, s44, 1024
  s_add_u32 s42, s42, s43
  buffer_load_dwordx4 v9, s[32:35], s42 offen lds
  s_add_u32 m0, s44, 2048
  s_add_u32 s42, s42, s43
  buffer_load_dwordx4 v9, s[32:35], s42 offen lds
  s_add_u32 m0, s44, 3072
  s_add_u32 s42, s42, s43
  buffer_load_dwordx4 v9, s[32:35], s42 offen lds
  s_add_u32 m0, s44, 4096
  s_add_u32 s42, s42, s43
  buffer_load_dwordx4 v9, s[32:35], s42 offen lds
  s_add_u32 m0, s44, 5120
  s_add_u32 s42, s42, s43
  buffer_load_dwordx4 v9, s[32:35], s42 offen lds
  v_and_b32 v10, 31, v0
  v_lshlrev_b32 v10, 2, v10
  v_add_u32 v10, 162816, v10
  ds_read_b32 v152, v10 offset:0
  ds_read_b32 v153, v10 offset:512
  ds_read_b32 v154, v10 offset:128
  ds_read_b32 v155, v10 offset:640
  ds_read_b32 v156, v10 offset:256
  ds_read_b32 v157, v10 offset:768
  ds_read_b32 v158, v10 offset:384
  ds_read_b32 v159, v10 offset:896
  v_mov_b32 v40, 161792
  ds_read_b32 v40, v40
  s_waitcnt vmcnt(6) lgkmcnt(0)
  v_readfirstlane_b32 s40, v40
  v_lshlrev_b32 v128, 16, v144
  v_and_b32 v129, 0xffff0000, v144
  v_lshlrev_b32 v130, 16, v145
  v_and_b32 v131, 0xffff0000, v145
  v_lshlrev_b32 v132, 16, v146
  v_and_b32 v133, 0xffff0000, v146
  v_lshlrev_b32 v134, 16, v147
  v_and_b32 v135, 0xffff0000, v147
  v_lshlrev_b32 v136, 16, v148
  v_and_b32 v137, 0xffff0000, v148
  v_lshlrev_b32 v138, 16, v149
  v_and_b32 v139, 0xffff0000, v149
  v_lshlrev_b32 v140, 16, v150
  v_and_b32 v141, 0xffff0000, v150
  v_lshlrev_b32 v142, 16, v151
  v_and_b32 v143, 0xffff0000, v151
  s_barrier
  s_setprio 3
  s_add_u32 m0, s44, 6144
  s_add_u32 s42, s42, s43
  buffer_load_dwordx4 v9, s[32:35], s42 offen lds
  s_add_u32 m0, s44, 7168
  s_add_u32 s42, s42, s43
  buffer_load_dwordx4 v9, s[32:35], s42 offen lds
  s_waitcnt vmcnt(7)
  ds_read_b64_tr_b16 v[48:49], v8 offset:0
  ds_read_b64_tr_b16 v[50:51], v8 offset:256
  ds_read_b128 v[16:19], v4 offset:0
  ds_read_b128 v[20:23], v4 offset:4096
  ds_read_b128 v[24:27], v4 offset:8192
  ds_read_b128 v[28:31], v4 offset:12288
  s_mov_b32 s46, 0
  s_mov_b32 s45, s44
L_gl_ffn_47:
  s_cmp_eq_u32 s46, 3
  s_cselect_b32 s45, 196608, s45
  s_cbranch_scc0 L_x0_48
  s_barrier
L_x0_48:
  s_waitcnt lgkmcnt(0)
  v_mfma_f32_32x32x16_bf16 v[64:79], v[48:51], v[16:19], v[64:79]
  s_add_u32 m0, s45, 0
  s_add_u32 s42, s42, s43
  buffer_load_dwordx4 v9, s[32:35], s42 offen lds
  s_waitcnt vmcnt(7)
  ds_read_b64_tr_b16 v[52:53], v8 offset:1024
  ds_read_b64_tr_b16 v[54:55], v8 offset:1280
  v_mfma_f32_32x32x16_bf16 v[80:95], v[48:51], v[20:23], v[80:95]
  ds_read_b128 v[32:35], v5 offset:0
  ds_read_b128 v[36:39], v5 offset:4096
  ds_read_b128 v[40:43], v5 offset:8192
  ds_read_b128 v[44:47], v5 offset:12288
  v_mfma_f32_32x32x16_bf16 v[96:111], v[48:51], v[24:27], v[96:111]
  v_mfma_f32_16x16x32_bf16 v[56:59], v[48:51], v[60:63], v[56:59]
  v_mfma_f32_32x32x16_bf16 v[112:127], v[48:51], v[28:31], v[112:127]
  s_waitcnt lgkmcnt(0)
  v_mfma_f32_32x32x16_bf16 v[64:79], v[52:55], v[32:35], v[64:79]
  s_add_u32 m0, s45, 1024
  s_add_u32 s42, s42, s43
  buffer_load_dwordx4 v9, s[32:35], s42 offen lds
  s_waitcnt vmcnt(7)
  ds_read_b64_tr_b16 v[48:49], v8 offset:2048
  ds_read_b64_tr_b16 v[50:51], v8 offset:2304
  v_mfma_f32_32x32x16_bf16 v[80:95], v[52:55], v[36:39], v[80:95]
  ds_read_b128 v[16:19], v6 offset:0
  ds_read_b128 v[20:23], v6 offset:4096
  ds_read_b128 v[24:27], v6 offset:8192
  ds_read_b128 v[28:31], v6 offset:12288
  v_mfma_f32_32x32x16_bf16 v[96:111], v[52:55], v[40:43], v[96:111]
  v_mfma_f32_16x16x32_bf16 v[56:59], v[52:55], v[60:63], v[56:59]
  v_mfma_f32_32x32x16_bf16 v[112:127], v[52:55], v[44:47], v[112:127]
  s_waitcnt lgkmcnt(0)
  v_mfma_f32_32x32x16_bf16 v[64:79], v[48:51], v[16:19], v[64:79]
  s_add_u32 m0, s45, 2048
  s_add_u32 s42, s42, s43
  buffer_load_dwordx4 v9, s[32:35], s42 offen lds
  s_waitcnt vmcnt(7)
  ds_read_b64_tr_b16 v[52:53], v8 offset:3072
  ds_read_b64_tr_b16 v[54:55], v8 offset:3328
  v_mfma_f32_32x32x16_bf16 v[80:95], v[48:51], v[20:23], v[80:95]
  ds_read_b128 v[32:35], v7 offset:0
  ds_read_b128 v[36:39], v7 offset:4096
  ds_read_b128 v[40:43], v7 offset:8192
  ds_read_b128 v[44:47], v7 offset:12288
  v_mfma_f32_32x32x16_bf16 v[96:111], v[48:51], v[24:27], v[96:111]
  v_mfma_f32_16x16x32_bf16 v[56:59], v[48:51], v[60:63], v[56:59]
  v_mfma_f32_32x32x16_bf16 v[112:127], v[48:51], v[28:31], v[112:127]
  s_waitcnt lgkmcnt(0)
  v_mfma_f32_32x32x16_bf16 v[64:79], v[52:55], v[32:35], v[64:79]
  s_add_u32 m0, s45, 3072
  s_add_u32 s42, s42, s43
  buffer_load_dwordx4 v9, s[32:35], s42 offen lds
  s_waitcnt vmcnt(7)
  ds_read_b64_tr_b16 v[48:49], v8 offset:4096
  ds_read_b64_tr_b16 v[50:51], v8 offset:4352
  v_mfma_f32_32x32x16_bf16 v[80:95], v[52:55], v[36:39], v[80:95]
  ds_read_b128 v[16:19], v4 offset:16384
  ds_read_b128 v[20:23], v4 offset:20480
  ds_read_b128 v[24:27], v4 offset:24576
  ds_read_b128 v[28:31], v4 offset:28672
  v_mfma_f32_32x32x16_bf16 v[96:111], v[52:55], v[40:43], v[96:111]
  v_mfma_f32_16x16x32_bf16 v[56:59], v[52:55], v[60:63], v[56:59]
  v_mfma_f32_32x32x16_bf16 v[112:127], v[52:55], v[44:47], v[112:127]
  s_waitcnt lgkmcnt(0)
  v_mfma_f32_32x32x16_bf16 v[64:79], v[48:51], v[16:19], v[64:79]
  s_add_u32 m0, s45, 4096
  s_add_u32 s42, s42, s43
  buffer_load_dwordx4 v9, s[32:35], s42 offen lds
  s_waitcnt vmcnt(7)
  ds_read_b64_tr_b16 v[52:53], v8 offset:5120
  ds_read_b64_tr_b16 v[54:55], v8 offset:5376
  v_mfma_f32_32x32x16_bf16 v[80:95], v[48:51], v[20:23], v[80:95]
  ds_read_b128 v[32:35], v5 offset:16384
  ds_read_b128 v[36:39], v5 offset:20480
  ds_read_b128 v[40:43], v5 offset:24576
  ds_read_b128 v[44:47], v5 offset:28672
  v_mfma_f32_32x32x16_bf16 v[96:111], v[48:51], v[24:27], v[96:111]
  v_mfma_f32_16x16x32_bf16 v[56:59], v[48:51], v[60:63], v[56:59]
  v_mfma_f32_32x32x16_bf16 v[112:127], v[48:51], v[28:31], v[112:127]
  s_waitcnt lgkmcnt(0)
  v_mfma_f32_32x32x16_bf16 v[64:79], v[52:55], v[32:35], v[64:79]
  s_add_u32 m0, s45, 5120
  s_add_u32 s42, s42, s43
  buffer_load_dwordx4 v9, s[32:35], s42 offen lds
  s_waitcnt vmcnt(7)
  ds_read_b64_tr_b16 v[48:49], v8 offset:6144
  ds_read_b64_tr_b16 v[50:51], v8 offset:6400
  v_mfma_f32_32x32x16_bf16 v[80:95], v[52:55], v[36:39], v[80:95]
  ds_read_b128 v[16:19], v6 offset:16384
  ds_read_b128 v[20:23], v6 offset:20480
  ds_read_b128 v[24:27], v6 offset:24576
  ds_read_b128 v[28:31], v6 offset:28672
  v_mfma_f32_32x32x16_bf16 v[96:111], v[52:55], v[40:43], v[96:111]
  v_mfma_f32_16x16x32_bf16 v[56:59], v[52:55], v[60:63], v[56:59]
  v_mfma_f32_32x32x16_bf16 v[112:127], v[52:55], v[44:47], v[112:127]
  s_waitcnt lgkmcnt(0)
  v_mfma_f32_32x32x16_bf16 v[64:79], v[48:51], v[16:19], v[64:79]
  s_add_u32 m0, s45, 6144
  s_add_u32 s42, s42, s43
  buffer_load_dwordx4 v9, s[32:35], s42 offen lds
  s_waitcnt vmcnt(7)
  ds_read_b64_tr_b16 v[52:53], v8 offset:7168
  ds_read_b64_tr_b16 v[54:55], v8 offset:7424
  v_mfma_f32_32x32x16_bf16 v[80:95], v[48:51], v[20:23], v[80:95]
  ds_read_b128 v[32:35], v7 offset:16384
  ds_read_b128 v[36:39], v7 offset:20480
  ds_read_b128 v[40:43], v7 offset:24576
  ds_read_b128 v[44:47], v7 offset:28672
  v_mfma_f32_32x32x16_bf16 v[96:111], v[48:51], v[24:27], v[96:111]
  v_mfma_f32_16x16x32_bf16 v[56:59], v[48:51], v[60:63], v[56:59]
  v_mfma_f32_32x32x16_bf16 v[112:127], v[48:51], v[28:31], v[112:127]
  s_waitcnt lgkmcnt(0)
  v_mfma_f32_32x32x16_bf16 v[64:79], v[52:55], v[32:35], v[64:79]
  s_add_u32 m0, s45, 7168
  s_add_u32 s42, s42, s43
  buffer_load_dwordx4 v9, s[32:35], s42 offen lds
  s_waitcnt vmcnt(7)
  ds_read_b64_tr_b16 v[48:49], v8 offset:0
  ds_read_b64_tr_b16 v[50:51], v8 offset:256
  v_mfma_f32_32x32x16_bf16 v[80:95], v[52:55], v[36:39], v[80:95]
  ds_read_b128 v[16:19], v4 offset:32768
  ds_read_b128 v[20:23], v4 offset:36864
  ds_read_b128 v[24:27], v4 offset:40960
  ds_read_b128 v[28:31], v4 offset:45056
  v_mfma_f32_32x32x16_bf16 v[96:111], v[52:55], v[40:43], v[96:111]
  v_mfma_f32_16x16x32_bf16 v[56:59], v[52:55], v[60:63], v[56:59]
  v_mfma_f32_32x32x16_bf16 v[112:127], v[52:55], v[44:47], v[112:127]
  v_add_u32 v4, 0x8000, v4
  v_add_u32 v5, 0x8000, v5
  v_add_u32 v6, 0x8000, v6
  v_add_u32 v7, 0x8000, v7
  s_add_u32 s46, s46, 1
  s_cmp_lt_u32 s46, 4
  s_cbranch_scc1 L_gl_ffn_47
  s_barrier
  s_setprio 2
  s_nop 7
  v_lshrrev_b32 v11, 5, v0
  v_lshlrev_b32 v11, 6, v11
  s_waitcnt lgkmcnt(0)
  ds_bpermute_b32 v16, v11, v56 offset:0
  ds_bpermute_b32 v17, v11, v57 offset:0
  ds_bpermute_b32 v18, v11, v58 offset:0
  ds_bpermute_b32 v19, v11, v59 offset:0
  ds_bpermute_b32 v20, v11, v56 offset:128
  ds_bpermute_b32 v21, v11, v57 offset:128
  ds_bpermute_b32 v22, v11, v58 offset:128
  ds_bpermute_b32 v23, v11, v59 offset:128
  ds_bpermute_b32 v24, v11, v56 offset:4
  ds_bpermute_b32 v25, v11, v57 offset:4
  ds_bpermute_b32 v26, v11, v58 offset:4
  ds_bpermute_b32 v27, v11, v59 offset:4
  ds_bpermute_b32 v28, v11, v56 offset:132
  ds_bpermute_b32 v29, v11, v57 offset:132
  ds_bpermute_b32 v30, v11, v58 offset:132
  ds_bpermute_b32 v31, v11, v59 offset:132
  v_mov_b32 v32, v152
  v_mov_b32 v33, v153
  v_mov_b32 v34, v154
  v_mov_b32 v35, v155
  v_mov_b32 v36, v156
  v_mov_b32 v37, v157
  v_mov_b32 v38, v158
  v_mov_b32 v39, v159
  s_mul_i32 s48, s26, 458752
  s_lshl_b32 s49, s51, 11
  s_add_u32 s48, s48, s49
  s_add_u32 s48, s48, 6291456
  v_lshlrev_b32 v10, 4, v0
  s_waitcnt lgkmcnt(0)
  v_fma_f32 v44, v16, v33, v128
  v_fma_f32 v45, v17, v33, v129
  v_fma_f32 v64, v64, v32, v44
  v_fma_f32 v65, v65, v32, v45
  v_max_f32 v44, 0, v64
  v_max_f32 v45, 0, v65
  v_mul_f32 v64, v44, v44
  v_mul_f32 v65, v45, v45
  v_cvt_pk_bf16_f32 v48, v64, v65
  v_fma_f32 v46, v18, v33, v130
  v_fma_f32 v47, v19, v33, v131
  v_fma_f32 v66, v66, v32, v46
  v_fma_f32 v67, v67, v32, v47
  v_max_f32 v46, 0, v66
  v_max_f32 v47, 0, v67
  v_mul_f32 v66, v46, v46
  v_mul_f32 v67, v47, v47
  v_cvt_pk_bf16_f32 v49, v66, v67
  v_fma_f32 v44, v20, v33, v132
  v_fma_f32 v45, v21, v33, v133
  v_fma_f32 v68, v68, v32, v44
  v_fma_f32 v69, v69, v32, v45
  v_max_f32 v44, 0, v68
  v_max_f32 v45, 0, v69
  v_mul_f32 v68, v44, v44
  v_mul_f32 v69, v45, v45
  v_cvt_pk_bf16_f32 v50, v68, v69
  v_fma_f32 v46, v22, v33, v134
  v_fma_f32 v47, v23, v33, v135
  v_fma_f32 v70, v70, v32, v46
  v_fma_f32 v71, v71, v32, v47
  v_max_f32 v46, 0, v70
  v_max_f32 v47, 0, v71
  v_mul_f32 v70, v46, v46
  v_mul_f32 v71, v47, v47
  v_cvt_pk_bf16_f32 v51, v70, v71
  s_add_u32 s49, s48, 0
  buffer_store_dwordx4 v[48:51], v10, s[28:31], s49 offen sc1
  v_fma_f32 v44, v24, v33, v136
  v_fma_f32 v45, v25, v33, v137
  v_fma_f32 v72, v72, v32, v44
  v_fma_f32 v73, v73, v32, v45
  v_max_f32 v44, 0, v72
  v_max_f32 v45, 0, v73
  v_mul_f32 v72, v44, v44
  v_mul_f32 v73, v45, v45
  v_cvt_pk_bf16_f32 v52, v72, v73
  v_fma_f32 v46, v26, v33, v138
  v_fma_f32 v47, v27, v33, v139
  v_fma_f32 v74, v74, v32, v46
  v_fma_f32 v75, v75, v32, v47
  v_max_f32 v46, 0, v74
  v_max_f32 v47, 0, v75
  v_mul_f32 v74, v46, v46
  v_mul_f32 v75, v47, v47
  v_cvt_pk_bf16_f32 v53, v74, v75
  v_fma_f32 v44, v28, v33, v140
  v_fma_f32 v45, v29, v33, v141
  v_fma_f32 v76, v76, v32, v44
  v_fma_f32 v77, v77, v32, v45
  v_max_f32 v44, 0, v76
  v_max_f32 v45, 0, v77
  v_mul_f32 v76, v44, v44
  v_mul_f32 v77, v45, v45
  v_cvt_pk_bf16_f32 v54, v76, v77
  v_fma_f32 v46, v30, v33, v142
  v_fma_f32 v47, v31, v33, v143
  v_fma_f32 v78, v78, v32, v46
  v_fma_f32 v79, v79, v32, v47
  v_max_f32 v46, 0, v78
  v_max_f32 v47, 0, v79
  v_mul_f32 v78, v46, v46
  v_mul_f32 v79, v47, v47
  v_cvt_pk_bf16_f32 v55, v78, v79
  s_add_u32 s49, s48, 1024
  buffer_store_dwordx4 v[52:55], v10, s[28:31], s49 offen sc1
  v_fma_f32 v44, v16, v35, v128
  v_fma_f32 v45, v17, v35, v129
  v_fma_f32 v80, v80, v34, v44
  v_fma_f32 v81, v81, v34, v45
  v_max_f32 v44, 0, v80
  v_max_f32 v45, 0, v81
  v_mul_f32 v80, v44, v44
  v_mul_f32 v81, v45, v45
  v_cvt_pk_bf16_f32 v48, v80, v81
  v_fma_f32 v46, v18, v35, v130
  v_fma_f32 v47, v19, v35, v131
  v_fma_f32 v82, v82, v34, v46
  v_fma_f32 v83, v83, v34, v47
  v_max_f32 v46, 0, v82
  v_max_f32 v47, 0, v83
  v_mul_f32 v82, v46, v46
  v_mul_f32 v83, v47, v47
  v_cvt_pk_bf16_f32 v49, v82, v83
  v_fma_f32 v44, v20, v35, v132
  v_fma_f32 v45, v21, v35, v133
  v_fma_f32 v84, v84, v34, v44
  v_fma_f32 v85, v85, v34, v45
  v_max_f32 v44, 0, v84
  v_max_f32 v45, 0, v85
  v_mul_f32 v84, v44, v44
  v_mul_f32 v85, v45, v45
  v_cvt_pk_bf16_f32 v50, v84, v85
  v_fma_f32 v46, v22, v35, v134
  v_fma_f32 v47, v23, v35, v135
  v_fma_f32 v86, v86, v34, v46
  v_fma_f32 v87, v87, v34, v47
  v_max_f32 v46, 0, v86
  v_max_f32 v47, 0, v87
  v_mul_f32 v86, v46, v46
  v_mul_f32 v87, v47, v47
  v_cvt_pk_bf16_f32 v51, v86, v87
  s_add_u32 s49, s48, 114688
  buffer_store_dwordx4 v[48:51], v10, s[28:31], s49 offen sc1
  v_fma_f32 v44, v24, v35, v136
  v_fma_f32 v45, v25, v35, v137
  v_fma_f32 v88, v88, v34, v44
  v_fma_f32 v89, v89, v34, v45
  v_max_f32 v44, 0, v88
  v_max_f32 v45, 0, v89
  v_mul_f32 v88, v44, v44
  v_mul_f32 v89, v45, v45
  v_cvt_pk_bf16_f32 v52, v88, v89
  v_fma_f32 v46, v26, v35, v138
  v_fma_f32 v47, v27, v35, v139
  v_fma_f32 v90, v90, v34, v46
  v_fma_f32 v91, v91, v34, v47
  v_max_f32 v46, 0, v90
  v_max_f32 v47, 0, v91
  v_mul_f32 v90, v46, v46
  v_mul_f32 v91, v47, v47
  v_cvt_pk_bf16_f32 v53, v90, v91
  v_fma_f32 v44, v28, v35, v140
  v_fma_f32 v45, v29, v35, v141
  v_fma_f32 v92, v92, v34, v44
  v_fma_f32 v93, v93, v34, v45
  v_max_f32 v44, 0, v92
  v_max_f32 v45, 0, v93
  v_mul_f32 v92, v44, v44
  v_mul_f32 v93, v45, v45
  v_cvt_pk_bf16_f32 v54, v92, v93
  v_fma_f32 v46, v30, v35, v142
  v_fma_f32 v47, v31, v35, v143
  v_fma_f32 v94, v94, v34, v46
  v_fma_f32 v95, v95, v34, v47
  v_max_f32 v46, 0, v94
  v_max_f32 v47, 0, v95
  v_mul_f32 v94, v46, v46
  v_mul_f32 v95, v47, v47
  v_cvt_pk_bf16_f32 v55, v94, v95
  s_add_u32 s49, s48, 115712
  buffer_store_dwordx4 v[52:55], v10, s[28:31], s49 offen sc1
  v_fma_f32 v44, v16, v37, v128
  v_fma_f32 v45, v17, v37, v129
  v_fma_f32 v96, v96, v36, v44
  v_fma_f32 v97, v97, v36, v45
  v_max_f32 v44, 0, v96
  v_max_f32 v45, 0, v97
  v_mul_f32 v96, v44, v44
  v_mul_f32 v97, v45, v45
  v_cvt_pk_bf16_f32 v48, v96, v97
  v_fma_f32 v46, v18, v37, v130
  v_fma_f32 v47, v19, v37, v131
  v_fma_f32 v98, v98, v36, v46
  v_fma_f32 v99, v99, v36, v47
  v_max_f32 v46, 0, v98
  v_max_f32 v47, 0, v99
  v_mul_f32 v98, v46, v46
  v_mul_f32 v99, v47, v47
  v_cvt_pk_bf16_f32 v49, v98, v99
  v_fma_f32 v44, v20, v37, v132
  v_fma_f32 v45, v21, v37, v133
  v_fma_f32 v100, v100, v36, v44
  v_fma_f32 v101, v101, v36, v45
  v_max_f32 v44, 0, v100
  v_max_f32 v45, 0, v101
  v_mul_f32 v100, v44, v44
  v_mul_f32 v101, v45, v45
  v_cvt_pk_bf16_f32 v50, v100, v101
  v_fma_f32 v46, v22, v37, v134
  v_fma_f32 v47, v23, v37, v135
  v_fma_f32 v102, v102, v36, v46
  v_fma_f32 v103, v103, v36, v47
  v_max_f32 v46, 0, v102
  v_max_f32 v47, 0, v103
  v_mul_f32 v102, v46, v46
  v_mul_f32 v103, v47, v47
  v_cvt_pk_bf16_f32 v51, v102, v103
  s_add_u32 s49, s48, 229376
  buffer_store_dwordx4 v[48:51], v10, s[28:31], s49 offen sc1
  v_fma_f32 v44, v24, v37, v136
  v_fma_f32 v45, v25, v37, v137
  v_fma_f32 v104, v104, v36, v44
  v_fma_f32 v105, v105, v36, v45
  v_max_f32 v44, 0, v104
  v_max_f32 v45, 0, v105
  v_mul_f32 v104, v44, v44
  v_mul_f32 v105, v45, v45
  v_cvt_pk_bf16_f32 v52, v104, v105
  v_fma_f32 v46, v26, v37, v138
  v_fma_f32 v47, v27, v37, v139
  v_fma_f32 v106, v106, v36, v46
  v_fma_f32 v107, v107, v36, v47
  v_max_f32 v46, 0, v106
  v_max_f32 v47, 0, v107
  v_mul_f32 v106, v46, v46
  v_mul_f32 v107, v47, v47
  v_cvt_pk_bf16_f32 v53, v106, v107
  v_fma_f32 v44, v28, v37, v140
  v_fma_f32 v45, v29, v37, v141
  v_fma_f32 v108, v108, v36, v44
  v_fma_f32 v109, v109, v36, v45
  v_max_f32 v44, 0, v108
  v_max_f32 v45, 0, v109
  v_mul_f32 v108, v44, v44
  v_mul_f32 v109, v45, v45
  v_cvt_pk_bf16_f32 v54, v108, v109
  v_fma_f32 v46, v30, v37, v142
  v_fma_f32 v47, v31, v37, v143
  v_fma_f32 v110, v110, v36, v46
  v_fma_f32 v111, v111, v36, v47
  v_max_f32 v46, 0, v110
  v_max_f32 v47, 0, v111
  v_mul_f32 v110, v46, v46
  v_mul_f32 v111, v47, v47
  v_cvt_pk_bf16_f32 v55, v110, v111
  s_add_u32 s49, s48, 230400
  buffer_store_dwordx4 v[52:55], v10, s[28:31], s49 offen sc1
  v_fma_f32 v44, v16, v39, v128
  v_fma_f32 v45, v17, v39, v129
  v_fma_f32 v112, v112, v38, v44
  v_fma_f32 v113, v113, v38, v45
  v_max_f32 v44, 0, v112
  v_max_f32 v45, 0, v113
  v_mul_f32 v112, v44, v44
  v_mul_f32 v113, v45, v45
  v_cvt_pk_bf16_f32 v48, v112, v113
  v_fma_f32 v46, v18, v39, v130
  v_fma_f32 v47, v19, v39, v131
  v_fma_f32 v114, v114, v38, v46
  v_fma_f32 v115, v115, v38, v47
  v_max_f32 v46, 0, v114
  v_max_f32 v47, 0, v115
  v_mul_f32 v114, v46, v46
  v_mul_f32 v115, v47, v47
  v_cvt_pk_bf16_f32 v49, v114, v115
  v_fma_f32 v44, v20, v39, v132
  v_fma_f32 v45, v21, v39, v133
  v_fma_f32 v116, v116, v38, v44
  v_fma_f32 v117, v117, v38, v45
  v_max_f32 v44, 0, v116
  v_max_f32 v45, 0, v117
  v_mul_f32 v116, v44, v44
  v_mul_f32 v117, v45, v45
  v_cvt_pk_bf16_f32 v50, v116, v117
  v_fma_f32 v46, v22, v39, v134
  v_fma_f32 v47, v23, v39, v135
  v_fma_f32 v118, v118, v38, v46
  v_fma_f32 v119, v119, v38, v47
  v_max_f32 v46, 0, v118
  v_max_f32 v47, 0, v119
  v_mul_f32 v118, v46, v46
  v_mul_f32 v119, v47, v47
  v_cvt_pk_bf16_f32 v51, v118, v119
  s_add_u32 s49, s48, 344064
  buffer_store_dwordx4 v[48:51], v10, s[28:31], s49 offen sc1
  v_fma_f32 v44, v24, v39, v136
  v_fma_f32 v45, v25, v39, v137
  v_fma_f32 v120, v120, v38, v44
  v_fma_f32 v121, v121, v38, v45
  v_max_f32 v44, 0, v120
  v_max_f32 v45, 0, v121
  v_mul_f32 v120, v44, v44
  v_mul_f32 v121, v45, v45
  v_cvt_pk_bf16_f32 v52, v120, v121
  v_fma_f32 v46, v26, v39, v138
  v_fma_f32 v47, v27, v39, v139
  v_fma_f32 v122, v122, v38, v46
  v_fma_f32 v123, v123, v38, v47
  v_max_f32 v46, 0, v122
  v_max_f32 v47, 0, v123
  v_mul_f32 v122, v46, v46
  v_mul_f32 v123, v47, v47
  v_cvt_pk_bf16_f32 v53, v122, v123
  v_fma_f32 v44, v28, v39, v140
  v_fma_f32 v45, v29, v39, v141
  v_fma_f32 v124, v124, v38, v44
  v_fma_f32 v125, v125, v38, v45
  v_max_f32 v44, 0, v124
  v_max_f32 v45, 0, v125
  v_mul_f32 v124, v44, v44
  v_mul_f32 v125, v45, v45
  v_cvt_pk_bf16_f32 v54, v124, v125
  v_fma_f32 v46, v30, v39, v142
  v_fma_f32 v47, v31, v39, v143
  v_fma_f32 v126, v126, v38, v46
  v_fma_f32 v127, v127, v38, v47
  v_max_f32 v46, 0, v126
  v_max_f32 v47, 0, v127
  v_mul_f32 v126, v46, v46
  v_mul_f32 v127, v47, v47
  v_cvt_pk_bf16_f32 v55, v126, v127
  s_add_u32 s49, s48, 345088
  buffer_store_dwordx4 v[52:55], v10, s[28:31], s49 offen sc1
  s_barrier
  s_lshl_b32 s48, s26, 8
  s_lshl_b32 s49, s51, 2
  s_add_u32 s48, s48, s49
  s_add_u32 s48, s48, 16781312
  s_waitcnt vmcnt(0)
  v_mov_b32 v12, s40
  v_mov_b32 v13, 0
  s_mov_b64 exec, 1
  buffer_store_dword v12, v13, s[28:31], s48 offen sc1
  s_mov_b64 exec, -1
  s_branch L_s3_gemm
L_ffn_skip:
  v_mov_b32 v40, 161792
  ds_read_b32 v40, v40
  s_waitcnt vmcnt(0) lgkmcnt(0)
  v_readfirstlane_b32 s40, v40
  s_barrier
  s_sleep 16
  s_sleep 16
  s_sleep 16
  s_barrier
  s_barrier
  s_barrier
  s_branch L_s3_gemm
L_s3_gemm:
  s_setprio 3
  s_and_b32 s96, s2, 7
  s_lshr_b32 s47, s2, 6
  s_lshl_b32 s47, s47, 3
  s_or_b32 s96, s96, s47
  s_bfe_u32 s97, s2, 0x30003
  s_and_b32 s98, s2, 7
  s_lshl_b32 s98, s98, 2
  s_bfe_u32 s47, s2, 0x20003
  s_add_u32 s98, s98, s47
  s_lshr_b32 s99, s2, 5
  s_sub_u32 s50, s3, 8
  s_cmp_lg_u32 s3, 9
  s_cbranch_scc1 L_co_49
  s_lshl_b32 s46, s97, 8
  s_add_u32 s46, s46, s96
  s_lshl_b32 s46, s46, 10
  s_add_u32 s46, s46, 14680064
  v_mov_b32 v152, -1
  v_mov_b32 v153, -1
  v_mov_b32 v154, -1
  v_mov_b32 v155, -1
  v_lshlrev_b32 v156, 4, v0
  buffer_store_dwordx4 v[152:155], v156, s[28:31], s46 offen sc1
  s_add_u32 s46, s46, 32768
  buffer_store_dwordx4 v[152:155], v156, s[28:31], s46 offen sc1
  s_add_u32 s46, s46, 32768
  buffer_store_dwordx4 v[152:155], v156, s[28:31], s46 offen sc1
  s_add_u32 s46, s46, 32768
  buffer_store_dwordx4 v[152:155], v156, s[28:31], s46 offen sc1
  s_add_u32 s46, s46, 32768
  buffer_store_dwordx4 v[152:155], v156, s[28:31], s46 offen sc1
  s_add_u32 s46, s46, 32768
  buffer_store_dwordx4 v[152:155], v156, s[28:31], s46 offen sc1
  s_add_u32 s46, s46, 32768
  buffer_store_dwordx4 v[152:155], v156, s[28:31], s46 offen sc1
  s_add_u32 s46, s46, 32768
  buffer_store_dwordx4 v[152:155], v156, s[28:31], s46 offen sc1
  s_add_u32 s46, s46, 32768
  s_lshl_b32 s48, s97, 8
  s_lshl_b32 s49, s96, 2
  s_add_u32 s48, s48, s49
  s_add_u32 s48, s48, 16785408
  s_waitcnt vmcnt(0)
  v_mov_b32 v157, s40
  v_mov_b32 v158, 0
  s_mov_b64 exec, 1
  buffer_store_dword v157, v158, s[28:31], s48 offen sc1
  s_mov_b64 exec, -1
L_co_49:
  s_mov_b32 s32, s16
  s_and_b32 s33, s17, 0xffff
  s_mov_b32 s34, 1835008
  s_mov_b32 s35, 0x20000
  v_lshrrev_b32 v4, 2, v0
  v_lshlrev_b32 v4, 10, v4
  v_and_b32 v5, 3, v0
  v_lshl_add_u32 v4, v5, 4, v4
  s_mul_i32 s44, s50, 6144
  s_add_u32 s44, s44, 132096
  v_lshrrev_b32 v6, 5, v0
  v_bfe_u32 v7, v0, 2, 2
  v_lshl_add_u32 v7, v6, 2, v7
  v_lshlrev_b32 v7, 6, v7
  v_bfe_u32 v8, v0, 4, 1
  v_lshl_add_u32 v7, v8, 5, v7
  v_and_b32 v8, 3, v0
  v_lshl_add_u32 v7, v8, 3, v7
  v_add_u32 v7, s44, v7
  v_lshlrev_b32 v1, 4, v0
  s_mul_i32 s45, s50, 28
  s_lshl_b32 s46, s45, 14
  s_lshl_b32 s47, s99, 7
  s_add_u32 s46, s46, s47
  s_mul_i32 s47, s98, 229376
  s_lshl_b32 s48, s45, 10
  s_add_u32 s47, s47, s48
  s_add_u32 s47, s47, 6291456
  s_add_u32 s48, s47, 114688
  v_mov_b32 v64, 0
  v_mov_b32 v65, 0
  v_mov_b32 v66, 0
  v_mov_b32 v67, 0
  v_mov_b32 v68, 0
  v_mov_b32 v69, 0
  v_mov_b32 v70, 0
  v_mov_b32 v71, 0
  v_mov_b32 v72, 0
  v_mov_b32 v73, 0
  v_mov_b32 v74, 0
  v_mov_b32 v75, 0
  v_mov_b32 v76, 0
  v_mov_b32 v77, 0
  v_mov_b32 v78, 0
  v_mov_b32 v79, 0
  v_mov_b32 v80, 0
  v_mov_b32 v81, 0
  v_mov_b32 v82, 0
  v_mov_b32 v83, 0
  v_mov_b32 v84, 0
  v_mov_b32 v85, 0
  v_mov_b32 v86, 0
  v_mov_b32 v87, 0
  v_mov_b32 v88, 0
  v_mov_b32 v89, 0
  v_mov_b32 v90, 0
  v_mov_b32 v91, 0
  v_mov_b32 v92, 0
  v_mov_b32 v93, 0
  v_mov_b32 v94, 0
  v_mov_b32 v95, 0
  v_mov_b32 v96, 0
  v_mov_b32 v97, 0
  v_mov_b32 v98, 0
  v_mov_b32 v99, 0
  v_mov_b32 v100, 0
  v_mov_b32 v101, 0
  v_mov_b32 v102, 0
  v_mov_b32 v103, 0
  v_mov_b32 v104, 0
  v_mov_b32 v105, 0
  v_mov_b32 v106, 0
  v_mov_b32 v107, 0
  v_mov_b32 v108, 0
  v_mov_b32 v109, 0
  v_mov_b32 v110, 0
  v_mov_b32 v111, 0
  v_mov_b32 v112, 0
  v_mov_b32 v113, 0
  v_mov_b32 v114, 0
  v_mov_b32 v115, 0
  v_mov_b32 v116, 0
  v_mov_b32 v117, 0
  v_mov_b32 v118, 0
  v_mov_b32 v119, 0
  v_mov_b32 v120, 0
  v_mov_b32 v121, 0
  v_mov_b32 v122, 0
  v_mov_b32 v123, 0
  v_mov_b32 v124, 0
  v_mov_b32 v125, 0
  v_mov_b32 v126, 0
  v_mov_b32 v127, 0
  s_lshr_b32 s51, s98, 1
  s_lshl_b32 s51, s51, 8
  s_mul_i32 s52, s50, 56
  s_add_u32 s51, s51, s52
  s_add_u32 s51, s51, 16781312
  v_lshlrev_b32 v2, 2, v0
  v_cmp_gt_u32 vcc, 14, v0
  s_mov_b32 s58, 0
  s_mov_b64 s[62:63], vcc
L_pf_50:
  buffer_load_dword v3, v2, s[28:31], s51 offen sc1
  s_add_u32 s58, s58, 1
  s_waitcnt vmcnt(0)
  v_cmp_eq_u32 vcc, s40, v3
  s_nop 1
  s_and_b64 vcc, vcc, s[62:63]
  s_cmp_eq_u64 vcc, s[62:63]
  s_cbranch_scc1 L_pfd_51
  s_cmp_ge_u32 s58, 0x4000
  s_cbranch_scc1 L_pfd_51
  s_sleep 2
  s_branch L_pf_50
L_pfd_51:
  s_add_u32 m0, s44, 0
  s_add_u32 s49, s46, 0
  buffer_load_dwordx4 v4, s[32:35], s49 offen lds
  s_add_u32 m0, s44, 1024
  s_add_u32 s49, s46, 64
  buffer_load_dwordx4 v4, s[32:35], s49 offen lds
  s_add_u32 s46, s46, 16384
  buffer_load_dwordx4 v[16:19], v1, s[28:31], s47 offen sc1
  buffer_load_dwordx4 v[20:23], v1, s[28:31], s48 offen sc1
  s_add_u32 s47, s47, 1024
  s_add_u32 s48, s48, 1024
  s_add_u32 m0, s44, 2048
  s_add_u32 s49, s46, 0
  buffer_load_dwordx4 v4, s[32:35], s49 offen lds
  s_add_u32 m0, s44, 3072
  s_add_u32 s49, s46, 64
  buffer_load_dwordx4 v4, s[32:35], s49 offen lds
  s_add_u32 s46, s46, 16384
  buffer_load_dwordx4 v[24:27], v1, s[28:31], s47 offen sc1
  buffer_load_dwordx4 v[28:31], v1, s[28:31], s48 offen sc1
  s_add_u32 s47, s47, 1024
  s_add_u32 s48, s48, 1024
  s_add_u32 m0, s44, 4096
  s_add_u32 s49, s46, 0
  buffer_load_dwordx4 v4, s[32:35], s49 offen lds
  s_add_u32 m0, s44, 5120
  s_add_u32 s49, s46, 64
  buffer_load_dwordx4 v4, s[32:35], s49 offen lds
  s_add_u32 s46, s46, 16384
  buffer_load_dwordx4 v[32:35], v1, s[28:31], s47 offen sc1
  buffer_load_dwordx4 v[36:39], v1, s[28:31], s48 offen sc1
  s_add_u32 s47, s47, 1024
  s_add_u32 s48, s48, 1024
  s_mov_b32 s43, 0
L_down_loop:
  s_waitcnt vmcnt(8)
  ds_read_b64_tr_b16 v[48:49], v7 offset:0
  ds_read_b64_tr_b16 v[50:51], v7 offset:512
  ds_read_b64_tr_b16 v[52:53], v7 offset:1024
  ds_read_b64_tr_b16 v[54:55], v7 offset:1536
  s_waitcnt lgkmcnt(0)
  v_mfma_f32_32x32x16_bf16 v[64:79], v[48:51], v[16:19], v[64:79]
  s_sleep 1
  v_mfma_f32_32x32x16_bf16 v[80:95], v[52:55], v[16:19], v[80:95]
  s_sleep 1
  v_mfma_f32_32x32x16_bf16 v[96:111], v[48:51], v[20:23], v[96:111]
  s_sleep 1
  v_mfma_f32_32x32x16_bf16 v[112:127], v[52:55], v[20:23], v[112:127]
  s_sleep 1
  s_add_u32 m0, s44, 0
  s_add_u32 s49, s46, 0
  buffer_load_dwordx4 v4, s[32:35], s49 offen lds
  s_add_u32 m0, s44, 1024
  s_add_u32 s49, s46, 64
  buffer_load_dwordx4 v4, s[32:35], s49 offen lds
  s_add_u32 s46, s46, 16384
  buffer_load_dwordx4 v[16:19], v1, s[28:31], s47 offen sc1
  buffer_load_dwordx4 v[20:23], v1, s[28:31], s48 offen sc1
  s_add_u32 s47, s47, 1024
  s_add_u32 s48, s48, 1024
  s_waitcnt vmcnt(8)
  ds_read_b64_tr_b16 v[48:49], v7 offset:2048
  ds_read_b64_tr_b16 v[50:51], v7 offset:2560
  ds_read_b64_tr_b16 v[52:53], v7 offset:3072
  ds_read_b64_tr_b16 v[54:55], v7 offset:3584
  s_waitcnt lgkmcnt(0)
  v_mfma_f32_32x32x16_bf16 v[64:79], v[48:51], v[24:27], v[64:79]
  s_sleep 1
  v_mfma_f32_32x32x16_bf16 v[80:95], v[52:55], v[24:27], v[80:95]
  s_sleep 1
  v_mfma_f32_32x32x16_bf16 v[96:111], v[48:51], v[28:31], v[96:111]
  s_sleep 1
  v_mfma_f32_32x32x16_bf16 v[112:127], v[52:55], v[28:31], v[112:127]
  s_sleep 1
  s_add_u32 m0, s44, 2048
  s_add_u32 s49, s46, 0
  buffer_load_dwordx4 v4, s[32:35], s49 offen lds
  s_add_u32 m0, s44, 3072
  s_add_u32 s49, s46, 64
  buffer_load_dwordx4 v4, s[32:35], s49 offen lds
  s_add_u32 s46, s46, 16384
  buffer_load_dwordx4 v[24:27], v1, s[28:31], s47 offen sc1
  buffer_load_dwordx4 v[28:31], v1, s[28:31], s48 offen sc1
  s_add_u32 s47, s47, 1024
  s_add_u32 s48, s48, 1024
  s_waitcnt vmcnt(8)
  ds_read_b64_tr_b16 v[48:49], v7 offset:4096
  ds_read_b64_tr_b16 v[50:51], v7 offset:4608
  ds_read_b64_tr_b16 v[52:53], v7 offset:5120
  ds_read_b64_tr_b16 v[54:55], v7 offset:5632
  s_waitcnt lgkmcnt(0)
  v_mfma_f32_32x32x16_bf16 v[64:79], v[48:51], v[32:35], v[64:79]
  s_sleep 1
  v_mfma_f32_32x32x16_bf16 v[80:95], v[52:55], v[32:35], v[80:95]
  s_sleep 1
  v_mfma_f32_32x32x16_bf16 v[96:111], v[48:51], v[36:39], v[96:111]
  s_sleep 1
  v_mfma_f32_32x32x16_bf16 v[112:127], v[52:55], v[36:39], v[112:127]
  s_sleep 1
  s_add_u32 m0, s44, 4096
  s_add_u32 s49, s46, 0
  buffer_load_dwordx4 v4, s[32:35], s49 offen lds
  s_add_u32 m0, s44, 5120
  s_add_u32 s49, s46, 64
  buffer_load_dwordx4 v4, s[32:35], s49 offen lds
  s_add_u32 s46, s46, 16384
  buffer_load_dwordx4 v[32:35], v1, s[28:31], s47 offen sc1
  buffer_load_dwordx4 v[36:39], v1, s[28:31], s48 offen sc1
  s_add_u32 s47, s47, 1024
  s_add_u32 s48, s48, 1024
  s_add_u32 s43, s43, 1
  s_cmp_lt_u32 s43, 8
  s_cbranch_scc1 L_down_loop
  s_waitcnt vmcnt(8)
  ds_read_b64_tr_b16 v[48:49], v7 offset:0
  ds_read_b64_tr_b16 v[50:51], v7 offset:512
  ds_read_b64_tr_b16 v[52:53], v7 offset:1024
  ds_read_b64_tr_b16 v[54:55], v7 offset:1536
  s_waitcnt lgkmcnt(0)
  v_mfma_f32_32x32x16_bf16 v[64:79], v[48:51], v[16:19], v[64:79]
  s_sleep 1
  v_mfma_f32_32x32x16_bf16 v[80:95], v[52:55], v[16:19], v[80:95]
  s_sleep 1
  v_mfma_f32_32x32x16_bf16 v[96:111], v[48:51], v[20:23], v[96:111]
  s_sleep 1
  v_mfma_f32_32x32x16_bf16 v[112:127], v[52:55], v[20:23], v[112:127]
  s_sleep 1
  s_add_u32 m0, s44, 0
  s_add_u32 s49, s46, 0
  buffer_load_dwordx4 v4, s[32:35], s49 offen lds
  s_add_u32 m0, s44, 1024
  s_add_u32 s49, s46, 64
  buffer_load_dwordx4 v4, s[32:35], s49 offen lds
  s_add_u32 s46, s46, 16384
  buffer_load_dwordx4 v[16:19], v1, s[28:31], s47 offen sc1
  buffer_load_dwordx4 v[20:23], v1, s[28:31], s48 offen sc1
  s_add_u32 s47, s47, 1024
  s_add_u32 s48, s48, 1024
  s_waitcnt vmcnt(8)
  ds_read_b64_tr_b16 v[48:49], v7 offset:2048
  ds_read_b64_tr_b16 v[50:51], v7 offset:2560
  ds_read_b64_tr_b16 v[52:53], v7 offset:3072
  ds_read_b64_tr_b16 v[54:55], v7 offset:3584
  s_waitcnt lgkmcnt(0)
  v_mfma_f32_32x32x16_bf16 v[64:79], v[48:51], v[24:27], v[64:79]
  s_sleep 1
  v_mfma_f32_32x32x16_bf16 v[80:95], v[52:55], v[24:27], v[80:95]
  s_sleep 1
  v_mfma_f32_32x32x16_bf16 v[96:111], v[48:51], v[28:31], v[96:111]
  s_sleep 1
  v_mfma_f32_32x32x16_bf16 v[112:127], v[52:55], v[28:31], v[112:127]
  s_sleep 1
  s_waitcnt vmcnt(4)
  ds_read_b64_tr_b16 v[48:49], v7 offset:4096
  ds_read_b64_tr_b16 v[50:51], v7 offset:4608
  ds_read_b64_tr_b16 v[52:53], v7 offset:5120
  ds_read_b64_tr_b16 v[54:55], v7 offset:5632
  s_waitcnt lgkmcnt(0)
  v_mfma_f32_32x32x16_bf16 v[64:79], v[48:51], v[32:35], v[64:79]
  s_sleep 1
  v_mfma_f32_32x32x16_bf16 v[80:95], v[52:55], v[32:35], v[80:95]
  s_sleep 1
  v_mfma_f32_32x32x16_bf16 v[96:111], v[48:51], v[36:39], v[96:111]
  s_sleep 1
  v_mfma_f32_32x32x16_bf16 v[112:127], v[52:55], v[36:39], v[112:127]
  s_sleep 1
  s_waitcnt vmcnt(0)
  ds_read_b64_tr_b16 v[48:49], v7 offset:0
  ds_read_b64_tr_b16 v[50:51], v7 offset:512
  ds_read_b64_tr_b16 v[52:53], v7 offset:1024
  ds_read_b64_tr_b16 v[54:55], v7 offset:1536
  s_waitcnt lgkmcnt(0)
  v_mfma_f32_32x32x16_bf16 v[64:79], v[48:51], v[16:19], v[64:79]
  s_sleep 1
  v_mfma_f32_32x32x16_bf16 v[80:95], v[52:55], v[16:19], v[80:95]
  s_sleep 1
  v_mfma_f32_32x32x16_bf16 v[96:111], v[48:51], v[20:23], v[96:111]
  s_sleep 1
  v_mfma_f32_32x32x16_bf16 v[112:127], v[52:55], v[20:23], v[112:127]
  s_sleep 1
  s_mov_b32 s32, s8
  s_and_b32 s33, s9, 0xffff
  s_mov_b32 s34, 524288
  s_mov_b32 s35, 0x20000
  v_lshrrev_b32 v4, 3, v0
  v_lshlrev_b32 v4, 10, v4
  v_and_b32 v5, 7, v0
  v_lshl_add_u32 v4, v5, 4, v4
  s_lshl_b32 s46, s50, 17
  s_lshl_b32 s47, s99, 7
  s_add_u32 s46, s46, s47
  buffer_load_dwordx4 v[16:19], v4, s[32:35], s46 offen
  s_add_u32 s46, s46, 8192
  buffer_load_dwordx4 v[20:23], v4, s[32:35], s46 offen
  s_add_u32 s46, s46, 8192
  buffer_load_dwordx4 v[24:27], v4, s[32:35], s46 offen
  s_add_u32 s46, s46, 8192
  buffer_load_dwordx4 v[28:31], v4, s[32:35], s46 offen
  s_add_u32 s46, s46, 8192
  buffer_load_dwordx4 v[32:35], v4, s[32:35], s46 offen
  s_add_u32 s46, s46, 8192
  buffer_load_dwordx4 v[36:39], v4, s[32:35], s46 offen
  s_add_u32 s46, s46, 8192
  buffer_load_dwordx4 v[40:43], v4, s[32:35], s46 offen
  s_add_u32 s46, s46, 8192
  buffer_load_dwordx4 v[44:47], v4, s[32:35], s46 offen
  s_add_u32 s46, s46, 8192
  buffer_load_dwordx4 v[128:131], v4, s[32:35], s46 offen
  s_add_u32 s46, s46, 8192
  buffer_load_dwordx4 v[132:135], v4, s[32:35], s46 offen
  s_add_u32 s46, s46, 8192
  buffer_load_dwordx4 v[136:139], v4, s[32:35], s46 offen
  s_add_u32 s46, s46, 8192
  buffer_load_dwordx4 v[140:143], v4, s[32:35], s46 offen
  s_add_u32 s46, s46, 8192
  buffer_load_dwordx4 v[144:147], v4, s[32:35], s46 offen
  s_add_u32 s46, s46, 8192
  buffer_load_dwordx4 v[148:151], v4, s[32:35], s46 offen
  s_add_u32 s46, s46, 8192
  buffer_load_dwordx4 v[152:155], v4, s[32:35], s46 offen
  s_add_u32 s46, s46, 8192
  buffer_load_dwordx4 v[156:159], v4, s[32:35], s46 offen
  s_add_u32 s46, s46, 8192
  s_lshl_b32 s48, s50, 2
  s_add_u32 s48, s48, 156672
  v_mov_b32 v2, s48
  v_mov_b32 v3, 1
  ds_write_b32 v2, v3
  s_branch L_tail_gemm
L_attn_slow:
  v_mov_b32 v88, 0
  v_mov_b32 v89, 0
  v_mov_b32 v90, 0
  v_mov_b32 v91, 0
  v_mov_b32 v92, 0
  v_mov_b32 v93, 0
  v_mov_b32 v94, 0
  v_mov_b32 v95, 0
  v_mov_b32 v96, 0
  v_mov_b32 v97, 0
  v_mov_b32 v98, 0
  v_mov_b32 v99, 0
  v_mov_b32 v100, 0
  v_mov_b32 v101, 0
  v_mov_b32 v102, 0
  v_mov_b32 v103, 0
  v_mov_b32 v136, 0xff61b1e6
  v_mov_b32 v137, v1
  v_mov_b32 v138, v2
  v_mov_b32 v141, v3
  s_mov_b32 s43, 0
L_slow_loop:
  ds_read_b128 v[12:15], v137
  ds_read_b128 v[20:23], v138
  ds_read_b128 v[24:27], v141
  s_waitcnt lgkmcnt(0)
  v_mfma_f32_32x32x16_bf16 v[40:55], v[12:15], v[4:7], 0
  v_add_u32 v137, 2064, v137
  v_add_u32 v138, 2064, v138
  v_add_u32 v141, 2064, v141
  s_nop 7
  s_nop 7
  v_max3_f32 v139, v40, v41, v42
  v_max3_f32 v139, v139, v43, v44
  v_max3_f32 v139, v139, v45, v46
  v_max3_f32 v139, v139, v47, v48
  v_max3_f32 v139, v139, v49, v50
  v_max3_f32 v139, v139, v51, v52
  v_max3_f32 v139, v139, v53, v54
  v_max_f32 v139, v139, v55
  s_nop 0
  v_mov_b32 v140, v139
  s_nop 1
  v_permlane32_swap_b32 v139, v140
  s_nop 1
  v_max3_f32 v139, v139, v140, v136
  v_sub_f32 v140, v136, v139
  v_exp_f32 v140, v140
  v_mov_b32 v136, v139
  v_sub_f32 v40, v40, v139
  v_sub_f32 v41, v41, v139
  v_sub_f32 v42, v42, v139
  v_sub_f32 v43, v43, v139
  v_sub_f32 v44, v44, v139
  v_sub_f32 v45, v45, v139
  v_sub_f32 v46, v46, v139
  v_sub_f32 v47, v47, v139
  v_sub_f32 v48, v48, v139
  v_sub_f32 v49, v49, v139
  v_sub_f32 v50, v50, v139
  v_sub_f32 v51, v51, v139
  v_sub_f32 v52, v52, v139
  v_sub_f32 v53, v53, v139
  v_sub_f32 v54, v54, v139
  v_sub_f32 v55, v55, v139
  v_exp_f32 v40, v40
  v_exp_f32 v41, v41
  v_exp_f32 v42, v42
  v_exp_f32 v43, v43
  v_exp_f32 v44, v44
  v_exp_f32 v45, v45
  v_exp_f32 v46, v46
  v_exp_f32 v47, v47
  v_exp_f32 v48, v48
  v_exp_f32 v49, v49
  v_exp_f32 v50, v50
  v_exp_f32 v51, v51
  v_exp_f32 v52, v52
  v_exp_f32 v53, v53
  v_exp_f32 v54, v54
  v_exp_f32 v55, v55
  v_mul_f32 v88, v88, v140
  v_mul_f32 v89, v89, v140
  v_mul_f32 v90, v90, v140
  v_mul_f32 v91, v91, v140
  v_mul_f32 v92, v92, v140
  v_mul_f32 v93, v93, v140
  v_mul_f32 v94, v94, v140
  v_mul_f32 v95, v95, v140
  v_mul_f32 v96, v96, v140
  v_cvt_pk_bf16_f32 v72, v40, v41
  v_cvt_pk_bf16_f32 v73, v42, v43
  v_cvt_pk_bf16_f32 v74, v44, v45
  v_cvt_pk_bf16_f32 v75, v46, v47
  v_cvt_pk_bf16_f32 v76, v48, v49
  v_cvt_pk_bf16_f32 v77, v50, v51
  v_cvt_pk_bf16_f32 v78, v52, v53
  v_cvt_pk_bf16_f32 v79, v54, v55
  s_nop 1
  v_mfma_f32_32x32x16_bf16 v[88:103], v[20:23], v[72:75], v[88:103]
  v_mfma_f32_32x32x16_bf16 v[88:103], v[24:27], v[76:79], v[88:103]
  s_add_u32 s43, s43, 1
  s_nop 7
  s_nop 7
  s_cmp_lt_u32 s43, 64
  s_cbranch_scc1 L_slow_loop
  s_branch L_attn_norm
L_s2_idle:
L_s3_attn:
  s_and_b32 s96, s2, 7
  s_lshr_b32 s47, s2, 6
  s_lshl_b32 s47, s47, 3
  s_or_b32 s96, s96, s47
  s_bfe_u32 s97, s2, 0x30003
  s_and_b32 s98, s2, 7
  s_lshl_b32 s98, s98, 2
  s_bfe_u32 s47, s2, 0x20003
  s_add_u32 s98, s98, s47
  s_lshr_b32 s99, s2, 5
  v_lshlrev_b32 v1, 4, v0
  s_lshl_b32 s43, s96, 16
  s_lshl_b32 s47, s3, 13
  s_add_u32 s44, s43, s47
  s_add_u32 s45, s44, 4194304
  s_add_u32 s44, s44, 2097152
  s_lshl_b32 s46, s97, 13
  s_add_u32 s43, s43, s46
  s_and_b32 s47, s3, 3
  s_lshl_b32 s47, s47, 11
  s_add_u32 s43, s43, s47
  s_mul_i32 s46, s3, 16512
  s_mov_b32 s56, s46
  v_add_u32 v126, s46, v1
  v_mov_b32 v120, v126
  v_lshrrev_b32 v2, 5, v0
  v_lshlrev_b32 v2, 8, v2
  v_and_b32 v3, 15, v0
  v_lshl_add_u32 v2, v3, 4, v2
  v_add_u32 v3, 1536, v2
  v_add_u32 v2, 1024, v2
  v_and_b32 v36, 31, v0
  v_cmp_lt_u32 vcc, 15, v36
  v_cmp_eq_u32 s[50:51], 16, v36
  v_mov_b32 v37, 196608
  v_mov_b32 v38, 2048
  s_nop 0
  v_cndmask_b32 v37, v37, v38, s[50:51]
  s_nop 0
  v_cndmask_b32 v2, v2, v37, vcc
  v_cndmask_b32 v3, v3, v37, vcc
  v_add_u32 v122, s46, v2
  v_add_u32 v123, s46, v3
  s_lshr_b32 s47, s3, 2
  s_mul_i32 s47, s47, 66048
  s_add_u32 s59, s47, 66048
  s_add_u32 s42, s46, 16512
  s_cmp_eq_u32 s42, s59
  s_cselect_b32 s47, 66048, 0
  s_sub_u32 s42, s42, s47
  v_add_u32 v121, s42, v1
  v_add_u32 v124, s42, v2
  v_add_u32 v125, s42, v3
  v_mul_u32_u24 v36, 2064, v0
  v_add_u32 v36, s46, v36
  v_mov_b32 v40, s41
  v_mov_b32 v41, s41
  v_mov_b32 v42, s41
  v_mov_b32 v43, s41
  v_lshlrev_b32 v37, 2, v0
  v_add_u32 v37, 156672, v37
  v_mov_b32 v38, 0
  v_mov_b32 v88, 0
  v_mov_b32 v89, 0
  v_mov_b32 v90, 0
  v_mov_b32 v91, 0
  v_mov_b32 v92, 0
  v_mov_b32 v93, 0
  v_mov_b32 v94, 0
  v_mov_b32 v95, 0
  v_mov_b32 v96, 0
  v_mov_b32 v97, 0
  v_mov_b32 v98, 0
  v_mov_b32 v99, 0
  v_mov_b32 v100, 0
  v_mov_b32 v101, 0
  v_mov_b32 v102, 0
  v_mov_b32 v103, 0
  v_mov_b32 v104, 0
  v_mov_b32 v105, 0
  v_mov_b32 v106, 0
  v_mov_b32 v107, 0
  v_mov_b32 v108, 0
  v_mov_b32 v109, 0
  v_mov_b32 v110, 0
  v_mov_b32 v111, 0
  v_mov_b32 v112, 0
  v_mov_b32 v113, 0
  v_mov_b32 v114, 0
  v_mov_b32 v115, 0
  v_mov_b32 v116, 0
  v_mov_b32 v117, 0
  v_mov_b32 v118, 0
  v_mov_b32 v119, 0
  v_mov_b32 v80, 0
  v_mov_b32 v28, 0
  v_mov_b32 v81, 0
  v_mov_b32 v29, 0
  v_mov_b32 v82, 0
  v_mov_b32 v30, 0
  v_mov_b32 v83, 0
  v_mov_b32 v31, 0
  v_mov_b32 v84, 0
  v_mov_b32 v32, 0
  v_mov_b32 v85, 0
  v_mov_b32 v33, 0
  v_mov_b32 v86, 0
  v_mov_b32 v34, 0
  v_mov_b32 v87, 0
  v_mov_b32 v35, 0
  v_lshrrev_b32 v127, 3, v0
  s_lshl_b32 s48, s3, 3
  v_add_u32 v127, s48, v127
  v_lshlrev_b32 v127, 10, v127
  v_and_b32 v39, 7, v0
  v_lshl_add_u32 v127, v39, 4, v127
  s_lshl_b32 s61, s98, 16
  s_lshl_b32 s48, s99, 7
  s_add_u32 s61, s61, s48
  s_lshl_b32 s60, s97, 3
  s_and_b32 s48, s3, 3
  s_lshl_b32 s48, s48, 1
  s_add_u32 s60, s60, s48
  s_lshr_b32 s48, s3, 2
  s_add_u32 s60, s60, s48
  s_lshl_b32 s60, s60, 5
  s_add_u32 s60, s60, s96
  s_lshl_b32 s60, s60, 10
  s_add_u32 s60, s60, 14680064
  s_barrier
  s_cmp_lg_u32 s3, 3
  s_cbranch_scc1 L_at_np
  s_lshr_b32 s47, s96, 1
  s_lshl_b32 s47, s47, 8
  s_add_u32 s47, s47, 16777216
  v_lshlrev_b32 v44, 2, v0
  v_cmp_gt_u32 vcc, 48, v0
  s_mov_b32 s58, 0
  s_mov_b64 s[62:63], vcc
L_pf_52:
  buffer_load_dword v45, v44, s[28:31], s47 offen sc1
  s_add_u32 s58, s58, 1
  s_waitcnt vmcnt(0)
  v_cmp_eq_u32 vcc, s40, v45
  s_nop 1
  s_and_b64 vcc, vcc, s[62:63]
  s_cmp_eq_u64 vcc, s[62:63]
  s_cbranch_scc1 L_pfd_53
  s_cmp_ge_u32 s58, 0x4000
  s_cbranch_scc1 L_pfd_53
  s_sleep 2
  s_branch L_pf_52
L_pfd_53:
L_at_np:
  s_barrier
  buffer_load_dwordx4 v[4:7], v1, s[28:31], s43 offen sc1
  buffer_load_dwordx4 v[8:11], v1, s[28:31], s43 offen offset:1024 sc1
  buffer_load_dwordx4 v[128:131], v1, s[28:31], s44 offen offset:0 sc1
  buffer_load_dwordx4 v[132:135], v1, s[28:31], s45 offen offset:0 sc1
  s_setprio 2
  s_mov_b64 exec, 0xff
  ds_write_b128 v36, v[40:43] offset:2048
  s_mov_b64 exec, -1
  s_cmp_lg_u32 s3, 0
  s_cbranch_scc1 L_at_nz
  s_mov_b64 exec, 0xffff
  ds_write_b32 v37, v38
  s_mov_b64 exec, -1
L_at_nz:
  buffer_load_dwordx4 v[136:139], v1, s[28:31], s44 offen offset:1024 sc1
  buffer_load_dwordx4 v[140:143], v1, s[28:31], s45 offen offset:1024 sc1
  buffer_load_dwordx4 v[144:147], v1, s[28:31], s44 offen offset:2048 sc1
  buffer_load_dwordx4 v[148:151], v1, s[28:31], s45 offen offset:2048 sc1
  s_waitcnt vmcnt(4)
  ds_write_b128 v126, v[128:131]
  ds_write_b128 v126, v[132:135] offset:1024
  buffer_load_dwordx4 v[152:155], v1, s[28:31], s44 offen offset:3072 sc1
  buffer_load_dwordx4 v[156:159], v1, s[28:31], s45 offen offset:3072 sc1
  s_add_u32 s44, s44, 4096
  s_add_u32 s45, s45, 4096
  ds_read_b128 v[12:15], v120
  ds_read_b128 v[20:23], v122
  ds_read_b128 v[24:27], v123
  s_waitcnt lgkmcnt(0)
  v_mfma_f32_32x32x16_bf16 v[40:55], v[12:15], v[4:7], 0
  s_nop 7
  s_nop 3
  s_waitcnt lgkmcnt(0)
  v_mfma_f32_32x32x16_bf16 v[56:71], v[12:15], v[8:11], 0
  s_waitcnt vmcnt(4)
  ds_write_b128 v126, v[136:139] offset:2064
  ds_write_b128 v126, v[140:143] offset:3088
  buffer_load_dwordx4 v[160:163], v1, s[28:31], s44 offen offset:0 sc1
  buffer_load_dwordx4 v[164:167], v1, s[28:31], s45 offen offset:0 sc1
  ds_read_b128 v[16:19], v120 offset:2064
  v_exp_f32 v40, v40
  v_exp_f32 v41, v41
  v_exp_f32 v42, v42
  v_exp_f32 v43, v43
  v_cvt_pk_bf16_f32 v72, v40, v41
  v_exp_f32 v44, v44
  v_exp_f32 v45, v45
  v_cvt_pk_bf16_f32 v73, v42, v43
  v_mfma_f32_32x32x16_bf16 v[104:119], v[28:31], v[80:83], v[104:119]
  v_exp_f32 v46, v46
  v_exp_f32 v47, v47
  v_cvt_pk_bf16_f32 v74, v44, v45
  v_exp_f32 v48, v48
  v_exp_f32 v49, v49
  v_cvt_pk_bf16_f32 v75, v46, v47
  v_exp_f32 v50, v50
  v_exp_f32 v51, v51
  v_mfma_f32_32x32x16_bf16 v[104:119], v[32:35], v[84:87], v[104:119]
  ds_read_b128 v[28:31], v122 offset:2064
  ds_read_b128 v[32:35], v123 offset:2064
  v_cvt_pk_bf16_f32 v76, v48, v49
  v_exp_f32 v52, v52
  v_exp_f32 v53, v53
  v_cvt_pk_bf16_f32 v77, v50, v51
  v_exp_f32 v54, v54
  v_exp_f32 v55, v55
  v_cvt_pk_bf16_f32 v78, v52, v53
  v_cvt_pk_bf16_f32 v79, v54, v55
  s_waitcnt lgkmcnt(2)
  v_mfma_f32_32x32x16_bf16 v[40:55], v[16:19], v[4:7], 0
  v_exp_f32 v56, v56
  v_exp_f32 v57, v57
  v_exp_f32 v58, v58
  v_exp_f32 v59, v59
  v_cvt_pk_bf16_f32 v80, v56, v57
  v_exp_f32 v60, v60
  v_exp_f32 v61, v61
  v_cvt_pk_bf16_f32 v81, v58, v59
  v_mfma_f32_32x32x16_bf16 v[88:103], v[20:23], v[72:75], v[88:103]
  v_exp_f32 v62, v62
  v_exp_f32 v63, v63
  v_cvt_pk_bf16_f32 v82, v60, v61
  v_exp_f32 v64, v64
  v_exp_f32 v65, v65
  v_cvt_pk_bf16_f32 v83, v62, v63
  v_exp_f32 v66, v66
  v_exp_f32 v67, v67
  v_mfma_f32_32x32x16_bf16 v[88:103], v[24:27], v[76:79], v[88:103]
  v_cvt_pk_bf16_f32 v84, v64, v65
  v_exp_f32 v68, v68
  v_exp_f32 v69, v69
  v_cvt_pk_bf16_f32 v85, v66, v67
  v_exp_f32 v70, v70
  v_exp_f32 v71, v71
  v_cvt_pk_bf16_f32 v86, v68, v69
  v_cvt_pk_bf16_f32 v87, v70, v71
  s_waitcnt lgkmcnt(0)
  v_mfma_f32_32x32x16_bf16 v[56:71], v[16:19], v[8:11], 0
  s_waitcnt vmcnt(4)
  ds_write_b128 v126, v[144:147] offset:4128
  ds_write_b128 v126, v[148:151] offset:5152
  buffer_load_dwordx4 v[128:131], v1, s[28:31], s44 offen offset:1024 sc1
  buffer_load_dwordx4 v[132:135], v1, s[28:31], s45 offen offset:1024 sc1
  ds_read_b128 v[12:15], v120 offset:4128
  v_exp_f32 v40, v40
  v_exp_f32 v41, v41
  v_exp_f32 v42, v42
  v_exp_f32 v43, v43
  v_cvt_pk_bf16_f32 v72, v40, v41
  v_exp_f32 v44, v44
  v_exp_f32 v45, v45
  v_cvt_pk_bf16_f32 v73, v42, v43
  v_mfma_f32_32x32x16_bf16 v[104:119], v[20:23], v[80:83], v[104:119]
  v_exp_f32 v46, v46
  v_exp_f32 v47, v47
  v_cvt_pk_bf16_f32 v74, v44, v45
  v_exp_f32 v48, v48
  v_exp_f32 v49, v49
  v_cvt_pk_bf16_f32 v75, v46, v47
  v_exp_f32 v50, v50
  v_exp_f32 v51, v51
  v_mfma_f32_32x32x16_bf16 v[104:119], v[24:27], v[84:87], v[104:119]
  ds_read_b128 v[20:23], v122 offset:4128
  ds_read_b128 v[24:27], v123 offset:4128
  v_cvt_pk_bf16_f32 v76, v48, v49
  v_exp_f32 v52, v52
  v_exp_f32 v53, v53
  v_cvt_pk_bf16_f32 v77, v50, v51
  v_exp_f32 v54, v54
  v_exp_f32 v55, v55
  v_cvt_pk_bf16_f32 v78, v52, v53
  v_cvt_pk_bf16_f32 v79, v54, v55
  s_waitcnt lgkmcnt(2)
  v_mfma_f32_32x32x16_bf16 v[40:55], v[12:15], v[4:7], 0
  v_exp_f32 v56, v56
  v_exp_f32 v57, v57
  v_exp_f32 v58, v58
  v_exp_f32 v59, v59
  v_cvt_pk_bf16_f32 v80, v56, v57
  v_exp_f32 v60, v60
  v_exp_f32 v61, v61
  v_cvt_pk_bf16_f32 v81, v58, v59
  v_mfma_f32_32x32x16_bf16 v[88:103], v[28:31], v[72:75], v[88:103]
  v_exp_f32 v62, v62
  v_exp_f32 v63, v63
  v_cvt_pk_bf16_f32 v82, v60, v61
  v_exp_f32 v64, v64
  v_exp_f32 v65, v65
  v_cvt_pk_bf16_f32 v83, v62, v63
  v_exp_f32 v66, v66
  v_exp_f32 v67, v67
  v_mfma_f32_32x32x16_bf16 v[88:103], v[32:35], v[76:79], v[88:103]
  v_cvt_pk_bf16_f32 v84, v64, v65
  v_exp_f32 v68, v68
  v_exp_f32 v69, v69
  v_cvt_pk_bf16_f32 v85, v66, v67
  v_exp_f32 v70, v70
  v_exp_f32 v71, v71
  v_cvt_pk_bf16_f32 v86, v68, v69
  v_cvt_pk_bf16_f32 v87, v70, v71
  s_waitcnt lgkmcnt(0)
  v_mfma_f32_32x32x16_bf16 v[56:71], v[12:15], v[8:11], 0
  s_waitcnt vmcnt(4)
  ds_write_b128 v126, v[152:155] offset:6192
  ds_write_b128 v126, v[156:159] offset:7216
  buffer_load_dwordx4 v[136:139], v1, s[28:31], s44 offen offset:2048 sc1
  buffer_load_dwordx4 v[140:143], v1, s[28:31], s45 offen offset:2048 sc1
  ds_read_b128 v[16:19], v120 offset:6192
  v_exp_f32 v40, v40
  v_exp_f32 v41, v41
  v_exp_f32 v42, v42
  v_exp_f32 v43, v43
  v_cvt_pk_bf16_f32 v72, v40, v41
  v_exp_f32 v44, v44
  v_exp_f32 v45, v45
  v_cvt_pk_bf16_f32 v73, v42, v43
  v_mfma_f32_32x32x16_bf16 v[104:119], v[28:31], v[80:83], v[104:119]
  v_exp_f32 v46, v46
  v_exp_f32 v47, v47
  v_cvt_pk_bf16_f32 v74, v44, v45
  v_exp_f32 v48, v48
  v_exp_f32 v49, v49
  v_cvt_pk_bf16_f32 v75, v46, v47
  v_exp_f32 v50, v50
  v_exp_f32 v51, v51
  v_mfma_f32_32x32x16_bf16 v[104:119], v[32:35], v[84:87], v[104:119]
  ds_read_b128 v[28:31], v122 offset:6192
  ds_read_b128 v[32:35], v123 offset:6192
  v_cvt_pk_bf16_f32 v76, v48, v49
  v_exp_f32 v52, v52
  v_exp_f32 v53, v53
  v_cvt_pk_bf16_f32 v77, v50, v51
  v_exp_f32 v54, v54
  v_exp_f32 v55, v55
  v_cvt_pk_bf16_f32 v78, v52, v53
  v_cvt_pk_bf16_f32 v79, v54, v55
  s_waitcnt lgkmcnt(2)
  v_mfma_f32_32x32x16_bf16 v[40:55], v[16:19], v[4:7], 0
  v_exp_f32 v56, v56
  v_exp_f32 v57, v57
  v_exp_f32 v58, v58
  v_exp_f32 v59, v59
  v_cvt_pk_bf16_f32 v80, v56, v57
  v_exp_f32 v60, v60
  v_exp_f32 v61, v61
  v_cvt_pk_bf16_f32 v81, v58, v59
  v_mfma_f32_32x32x16_bf16 v[88:103], v[20:23], v[72:75], v[88:103]
  v_exp_f32 v62, v62
  v_exp_f32 v63, v63
  v_cvt_pk_bf16_f32 v82, v60, v61
  v_exp_f32 v64, v64
  v_exp_f32 v65, v65
  v_cvt_pk_bf16_f32 v83, v62, v63
  v_exp_f32 v66, v66
  v_exp_f32 v67, v67
  v_mfma_f32_32x32x16_bf16 v[88:103], v[24:27], v[76:79], v[88:103]
  v_cvt_pk_bf16_f32 v84, v64, v65
  v_exp_f32 v68, v68
  v_exp_f32 v69, v69
  v_cvt_pk_bf16_f32 v85, v66, v67
  v_exp_f32 v70, v70
  v_exp_f32 v71, v71
  v_cvt_pk_bf16_f32 v86, v68, v69
  v_cvt_pk_bf16_f32 v87, v70, v71
  s_setprio 1
  s_waitcnt lgkmcnt(0)
  v_mfma_f32_32x32x16_bf16 v[56:71], v[16:19], v[8:11], 0
  s_waitcnt vmcnt(4)
  ds_write_b128 v126, v[160:163] offset:8256
  ds_write_b128 v126, v[164:167] offset:9280
  buffer_load_dwordx4 v[144:147], v1, s[28:31], s44 offen offset:3072 sc1
  buffer_load_dwordx4 v[148:151], v1, s[28:31], s45 offen offset:3072 sc1
  ds_read_b128 v[12:15], v120 offset:8256
  v_exp_f32 v40, v40
  v_exp_f32 v41, v41
  v_exp_f32 v42, v42
  v_exp_f32 v43, v43
  v_cvt_pk_bf16_f32 v72, v40, v41
  v_exp_f32 v44, v44
  v_exp_f32 v45, v45
  v_cvt_pk_bf16_f32 v73, v42, v43
  v_mfma_f32_32x32x16_bf16 v[104:119], v[20:23], v[80:83], v[104:119]
  v_exp_f32 v46, v46
  v_exp_f32 v47, v47
  v_cvt_pk_bf16_f32 v74, v44, v45
  v_exp_f32 v48, v48
  v_exp_f32 v49, v49
  v_cvt_pk_bf16_f32 v75, v46, v47
  v_exp_f32 v50, v50
  v_exp_f32 v51, v51
  v_mfma_f32_32x32x16_bf16 v[104:119], v[24:27], v[84:87], v[104:119]
  ds_read_b128 v[20:23], v122 offset:8256
  ds_read_b128 v[24:27], v123 offset:8256
  v_cvt_pk_bf16_f32 v76, v48, v49
  v_exp_f32 v52, v52
  v_exp_f32 v53, v53
  v_cvt_pk_bf16_f32 v77, v50, v51
  v_exp_f32 v54, v54
  v_exp_f32 v55, v55
  v_cvt_pk_bf16_f32 v78, v52, v53
  v_cvt_pk_bf16_f32 v79, v54, v55
  s_waitcnt lgkmcnt(2)
  v_mfma_f32_32x32x16_bf16 v[40:55], v[12:15], v[4:7], 0
  v_exp_f32 v56, v56
  v_exp_f32 v57, v57
  v_exp_f32 v58, v58
  v_exp_f32 v59, v59
  v_cvt_pk_bf16_f32 v80, v56, v57
  v_exp_f32 v60, v60
  v_exp_f32 v61, v61
  v_cvt_pk_bf16_f32 v81, v58, v59
  v_mfma_f32_32x32x16_bf16 v[88:103], v[28:31], v[72:75], v[88:103]
  v_exp_f32 v62, v62
  v_exp_f32 v63, v63
  v_cvt_pk_bf16_f32 v82, v60, v61
  v_exp_f32 v64, v64
  v_exp_f32 v65, v65
  v_cvt_pk_bf16_f32 v83, v62, v63
  v_exp_f32 v66, v66
  v_exp_f32 v67, v67
  v_mfma_f32_32x32x16_bf16 v[88:103], v[32:35], v[76:79], v[88:103]
  v_cvt_pk_bf16_f32 v84, v64, v65
  v_exp_f32 v68, v68
  v_exp_f32 v69, v69
  v_cvt_pk_bf16_f32 v85, v66, v67
  v_exp_f32 v70, v70
  v_exp_f32 v71, v71
  v_cvt_pk_bf16_f32 v86, v68, v69
  v_cvt_pk_bf16_f32 v87, v70, v71
  s_waitcnt lgkmcnt(0)
  v_mfma_f32_32x32x16_bf16 v[56:71], v[12:15], v[8:11], 0
  s_waitcnt vmcnt(4)
  ds_write_b128 v126, v[128:131] offset:10320
  ds_write_b128 v126, v[132:135] offset:11344
  ds_read_b128 v[16:19], v120 offset:10320
  v_exp_f32 v40, v40
  v_exp_f32 v41, v41
  v_exp_f32 v42, v42
  v_exp_f32 v43, v43
  v_cvt_pk_bf16_f32 v72, v40, v41
  v_exp_f32 v44, v44
  v_exp_f32 v45, v45
  v_cvt_pk_bf16_f32 v73, v42, v43
  v_mfma_f32_32x32x16_bf16 v[104:119], v[28:31], v[80:83], v[104:119]
  v_exp_f32 v46, v46
  v_exp_f32 v47, v47
  v_cvt_pk_bf16_f32 v74, v44, v45
  v_exp_f32 v48, v48
  v_exp_f32 v49, v49
  v_cvt_pk_bf16_f32 v75, v46, v47
  v_exp_f32 v50, v50
  v_exp_f32 v51, v51
  v_mfma_f32_32x32x16_bf16 v[104:119], v[32:35], v[84:87], v[104:119]
  ds_read_b128 v[28:31], v122 offset:10320
  ds_read_b128 v[32:35], v123 offset:10320
  v_cvt_pk_bf16_f32 v76, v48, v49
  v_exp_f32 v52, v52
  v_exp_f32 v53, v53
  v_cvt_pk_bf16_f32 v77, v50, v51
  v_exp_f32 v54, v54
  v_exp_f32 v55, v55
  v_cvt_pk_bf16_f32 v78, v52, v53
  v_cvt_pk_bf16_f32 v79, v54, v55
  s_waitcnt lgkmcnt(2)
  v_mfma_f32_32x32x16_bf16 v[40:55], v[16:19], v[4:7], 0
  v_exp_f32 v56, v56
  v_exp_f32 v57, v57
  v_exp_f32 v58, v58
  v_exp_f32 v59, v59
  v_cvt_pk_bf16_f32 v80, v56, v57
  v_exp_f32 v60, v60
  v_exp_f32 v61, v61
  v_cvt_pk_bf16_f32 v81, v58, v59
  v_mfma_f32_32x32x16_bf16 v[88:103], v[20:23], v[72:75], v[88:103]
  v_exp_f32 v62, v62
  v_exp_f32 v63, v63
  v_cvt_pk_bf16_f32 v82, v60, v61
  v_exp_f32 v64, v64
  v_exp_f32 v65, v65
  v_cvt_pk_bf16_f32 v83, v62, v63
  v_exp_f32 v66, v66
  v_exp_f32 v67, v67
  v_mfma_f32_32x32x16_bf16 v[88:103], v[24:27], v[76:79], v[88:103]
  v_cvt_pk_bf16_f32 v84, v64, v65
  v_exp_f32 v68, v68
  v_exp_f32 v69, v69
  v_cvt_pk_bf16_f32 v85, v66, v67
  v_exp_f32 v70, v70
  v_exp_f32 v71, v71
  v_cvt_pk_bf16_f32 v86, v68, v69
  v_cvt_pk_bf16_f32 v87, v70, v71
  s_setprio 0
  s_waitcnt lgkmcnt(0)
  v_mfma_f32_32x32x16_bf16 v[56:71], v[16:19], v[8:11], 0
  s_waitcnt vmcnt(2)
  ds_write_b128 v126, v[136:139] offset:12384
  ds_write_b128 v126, v[140:143] offset:13408
  ds_read_b128 v[12:15], v120 offset:12384
  v_exp_f32 v40, v40
  v_exp_f32 v41, v41
  v_exp_f32 v42, v42
  v_exp_f32 v43, v43
  v_cvt_pk_bf16_f32 v72, v40, v41
  v_exp_f32 v44, v44
  v_exp_f32 v45, v45
  v_cvt_pk_bf16_f32 v73, v42, v43
  v_mfma_f32_32x32x16_bf16 v[104:119], v[20:23], v[80:83], v[104:119]
  v_exp_f32 v46, v46
  v_exp_f32 v47, v47
  v_cvt_pk_bf16_f32 v74, v44, v45
  v_exp_f32 v48, v48
  v_exp_f32 v49, v49
  v_cvt_pk_bf16_f32 v75, v46, v47
  v_exp_f32 v50, v50
  v_exp_f32 v51, v51
  v_mfma_f32_32x32x16_bf16 v[104:119], v[24:27], v[84:87], v[104:119]
  ds_read_b128 v[20:23], v122 offset:12384
  ds_read_b128 v[24:27], v123 offset:12384
  v_cvt_pk_bf16_f32 v76, v48, v49
  v_exp_f32 v52, v52
  v_exp_f32 v53, v53
  v_cvt_pk_bf16_f32 v77, v50, v51
  v_exp_f32 v54, v54
  v_exp_f32 v55, v55
  v_cvt_pk_bf16_f32 v78, v52, v53
  v_cvt_pk_bf16_f32 v79, v54, v55
  s_waitcnt lgkmcnt(2)
  v_mfma_f32_32x32x16_bf16 v[40:55], v[12:15], v[4:7], 0
  v_exp_f32 v56, v56
  v_exp_f32 v57, v57
  v_exp_f32 v58, v58
  v_exp_f32 v59, v59
  v_cvt_pk_bf16_f32 v80, v56, v57
  v_exp_f32 v60, v60
  v_exp_f32 v61, v61
  v_cvt_pk_bf16_f32 v81, v58, v59
  v_mfma_f32_32x32x16_bf16 v[88:103], v[28:31], v[72:75], v[88:103]
  v_exp_f32 v62, v62
  v_exp_f32 v63, v63
  v_cvt_pk_bf16_f32 v82, v60, v61
  v_exp_f32 v64, v64
  v_exp_f32 v65, v65
  v_cvt_pk_bf16_f32 v83, v62, v63
  v_exp_f32 v66, v66
  v_exp_f32 v67, v67
  v_mfma_f32_32x32x16_bf16 v[88:103], v[32:35], v[76:79], v[88:103]
  v_cvt_pk_bf16_f32 v84, v64, v65
  v_exp_f32 v68, v68
  v_exp_f32 v69, v69
  v_cvt_pk_bf16_f32 v85, v66, v67
  v_exp_f32 v70, v70
  v_exp_f32 v71, v71
  v_cvt_pk_bf16_f32 v86, v68, v69
  v_cvt_pk_bf16_f32 v87, v70, v71
  s_waitcnt lgkmcnt(0)
  v_mfma_f32_32x32x16_bf16 v[56:71], v[12:15], v[8:11], 0
  s_waitcnt vmcnt(0)
  ds_write_b128 v126, v[144:147] offset:14448
  ds_write_b128 v126, v[148:151] offset:15472
  ds_read_b128 v[16:19], v120 offset:14448
  v_exp_f32 v40, v40
  v_exp_f32 v41, v41
  v_exp_f32 v42, v42
  v_exp_f32 v43, v43
  v_cvt_pk_bf16_f32 v72, v40, v41
  v_exp_f32 v44, v44
  v_exp_f32 v45, v45
  v_cvt_pk_bf16_f32 v73, v42, v43
  v_mfma_f32_32x32x16_bf16 v[104:119], v[28:31], v[80:83], v[104:119]
  v_exp_f32 v46, v46
  v_exp_f32 v47, v47
  v_cvt_pk_bf16_f32 v74, v44, v45
  v_exp_f32 v48, v48
  v_exp_f32 v49, v49
  v_cvt_pk_bf16_f32 v75, v46, v47
  v_exp_f32 v50, v50
  v_exp_f32 v51, v51
  v_mfma_f32_32x32x16_bf16 v[104:119], v[32:35], v[84:87], v[104:119]
  ds_read_b128 v[28:31], v122 offset:14448
  ds_read_b128 v[32:35], v123 offset:14448
  v_cvt_pk_bf16_f32 v76, v48, v49
  v_exp_f32 v52, v52
  v_exp_f32 v53, v53
  v_cvt_pk_bf16_f32 v77, v50, v51
  v_exp_f32 v54, v54
  v_exp_f32 v55, v55
  v_cvt_pk_bf16_f32 v78, v52, v53
  v_cvt_pk_bf16_f32 v79, v54, v55
  s_waitcnt lgkmcnt(2)
  v_mfma_f32_32x32x16_bf16 v[40:55], v[16:19], v[4:7], 0
  v_exp_f32 v56, v56
  v_exp_f32 v57, v57
  v_exp_f32 v58, v58
  v_exp_f32 v59, v59
  v_cvt_pk_bf16_f32 v80, v56, v57
  v_exp_f32 v60, v60
  v_exp_f32 v61, v61
  v_cvt_pk_bf16_f32 v81, v58, v59
  v_mfma_f32_32x32x16_bf16 v[88:103], v[20:23], v[72:75], v[88:103]
  v_exp_f32 v62, v62
  v_exp_f32 v63, v63
  v_cvt_pk_bf16_f32 v82, v60, v61
  v_exp_f32 v64, v64
  v_exp_f32 v65, v65
  v_cvt_pk_bf16_f32 v83, v62, v63
  v_exp_f32 v66, v66
  v_exp_f32 v67, v67
  v_mfma_f32_32x32x16_bf16 v[88:103], v[24:27], v[76:79], v[88:103]
  v_cvt_pk_bf16_f32 v84, v64, v65
  v_exp_f32 v68, v68
  v_exp_f32 v69, v69
  v_cvt_pk_bf16_f32 v85, v66, v67
  v_exp_f32 v70, v70
  v_exp_f32 v71, v71
  v_cvt_pk_bf16_f32 v86, v68, v69
  v_cvt_pk_bf16_f32 v87, v70, v71
  s_waitcnt lgkmcnt(0)
  s_barrier
  v_mfma_f32_32x32x16_bf16 v[56:71], v[16:19], v[8:11], 0
  ds_read_b128 v[12:15], v121 offset:0
  v_exp_f32 v40, v40
  v_exp_f32 v41, v41
  v_exp_f32 v42, v42
  v_exp_f32 v43, v43
  v_cvt_pk_bf16_f32 v72, v40, v41
  v_exp_f32 v44, v44
  v_exp_f32 v45, v45
  v_cvt_pk_bf16_f32 v73, v42, v43
  v_mfma_f32_32x32x16_bf16 v[104:119], v[20:23], v[80:83], v[104:119]
  v_exp_f32 v46, v46
  v_exp_f32 v47, v47
  v_cvt_pk_bf16_f32 v74, v44, v45
  v_exp_f32 v48, v48
  v_exp_f32 v49, v49
  v_cvt_pk_bf16_f32 v75, v46, v47
  v_exp_f32 v50, v50
  v_exp_f32 v51, v51
  v_mfma_f32_32x32x16_bf16 v[104:119], v[24:27], v[84:87], v[104:119]
  ds_read_b128 v[20:23], v124 offset:0
  ds_read_b128 v[24:27], v125 offset:0
  v_cvt_pk_bf16_f32 v76, v48, v49
  v_exp_f32 v52, v52
  v_exp_f32 v53, v53
  v_cvt_pk_bf16_f32 v77, v50, v51
  v_exp_f32 v54, v54
  v_exp_f32 v55, v55
  v_cvt_pk_bf16_f32 v78, v52, v53
  v_cvt_pk_bf16_f32 v79, v54, v55
  s_waitcnt lgkmcnt(2)
  v_mfma_f32_32x32x16_bf16 v[40:55], v[12:15], v[4:7], 0
  v_exp_f32 v56, v56
  v_exp_f32 v57, v57
  v_exp_f32 v58, v58
  v_exp_f32 v59, v59
  v_cvt_pk_bf16_f32 v80, v56, v57
  v_exp_f32 v60, v60
  v_exp_f32 v61, v61
  v_cvt_pk_bf16_f32 v81, v58, v59
  v_mfma_f32_32x32x16_bf16 v[88:103], v[28:31], v[72:75], v[88:103]
  v_exp_f32 v62, v62
  v_exp_f32 v63, v63
  v_cvt_pk_bf16_f32 v82, v60, v61
  v_exp_f32 v64, v64
  v_exp_f32 v65, v65
  v_cvt_pk_bf16_f32 v83, v62, v63
  v_exp_f32 v66, v66
  v_exp_f32 v67, v67
  v_mfma_f32_32x32x16_bf16 v[88:103], v[32:35], v[76:79], v[88:103]
  v_cvt_pk_bf16_f32 v84, v64, v65
  v_exp_f32 v68, v68
  v_exp_f32 v69, v69
  v_cvt_pk_bf16_f32 v85, v66, v67
  v_exp_f32 v70, v70
  v_exp_f32 v71, v71
  v_cvt_pk_bf16_f32 v86, v68, v69
  v_cvt_pk_bf16_f32 v87, v70, v71
  s_setprio 2
  v_mov_b32 v120, v121
  v_mov_b32 v122, v124
  v_mov_b32 v123, v125
  s_add_u32 s42, s42, 16512
  s_cmp_eq_u32 s42, s59
  s_cselect_b32 s46, 66048, 0
  s_sub_u32 s42, s42, s46
  v_add_u32 v121, s42, v1
  v_add_u32 v124, s42, v2
  v_add_u32 v125, s42, v3
  s_mov_b32 s32, s4
  s_and_b32 s33, s5, 0xffff
  s_mov_b32 s34, 2097152
  s_mov_b32 s35, 0x20000
  buffer_load_dwordx4 v[160:163], v127, s[32:35], s61 offen
  s_mov_b32 s36, s18
  s_and_b32 s37, s19, 0xffff
  s_mov_b32 s38, 1024
  s_mov_b32 s39, 0x20000
  v_and_b32 v36, 7, v0
  v_lshlrev_b32 v36, 4, v36
  s_lshl_b32 s48, s99, 7
  buffer_load_dwordx4 v[164:167], v36, s[36:39], s48 offen
  s_mov_b32 s43, 0
L_attn_loop:
  s_cmp_eq_u32 s43, 1
  s_cbranch_scc0 L_ap1
  s_setprio 1
L_ap1:
  s_cmp_eq_u32 s43, 2
  s_cbranch_scc0 L_ap2
  s_setprio 0
L_ap2:
  s_waitcnt lgkmcnt(0)
  v_mfma_f32_32x32x16_bf16 v[56:71], v[12:15], v[8:11], 0
  ds_read_b128 v[16:19], v120 offset:2064
  v_exp_f32 v40, v40
  v_exp_f32 v41, v41
  v_exp_f32 v42, v42
  v_exp_f32 v43, v43
  v_cvt_pk_bf16_f32 v72, v40, v41
  v_exp_f32 v44, v44
  v_exp_f32 v45, v45
  v_cvt_pk_bf16_f32 v73, v42, v43
  v_mfma_f32_32x32x16_bf16 v[104:119], v[28:31], v[80:83], v[104:119]
  v_exp_f32 v46, v46
  v_exp_f32 v47, v47
  v_cvt_pk_bf16_f32 v74, v44, v45
  v_exp_f32 v48, v48
  v_exp_f32 v49, v49
  v_cvt_pk_bf16_f32 v75, v46, v47
  v_exp_f32 v50, v50
  v_exp_f32 v51, v51
  v_mfma_f32_32x32x16_bf16 v[104:119], v[32:35], v[84:87], v[104:119]
  ds_read_b128 v[28:31], v122 offset:2064
  ds_read_b128 v[32:35], v123 offset:2064
  v_cvt_pk_bf16_f32 v76, v48, v49
  v_exp_f32 v52, v52
  v_exp_f32 v53, v53
  v_cvt_pk_bf16_f32 v77, v50, v51
  v_exp_f32 v54, v54
  v_exp_f32 v55, v55
  v_cvt_pk_bf16_f32 v78, v52, v53
  v_cvt_pk_bf16_f32 v79, v54, v55
  s_waitcnt lgkmcnt(2)
  v_mfma_f32_32x32x16_bf16 v[40:55], v[16:19], v[4:7], 0
  v_exp_f32 v56, v56
  v_exp_f32 v57, v57
  v_exp_f32 v58, v58
  v_exp_f32 v59, v59
  v_cvt_pk_bf16_f32 v80, v56, v57
  v_exp_f32 v60, v60
  v_exp_f32 v61, v61
  v_cvt_pk_bf16_f32 v81, v58, v59
  v_mfma_f32_32x32x16_bf16 v[88:103], v[20:23], v[72:75], v[88:103]
  v_exp_f32 v62, v62
  v_exp_f32 v63, v63
  v_cvt_pk_bf16_f32 v82, v60, v61
  v_exp_f32 v64, v64
  v_exp_f32 v65, v65
  v_cvt_pk_bf16_f32 v83, v62, v63
  v_exp_f32 v66, v66
  v_exp_f32 v67, v67
  v_mfma_f32_32x32x16_bf16 v[88:103], v[24:27], v[76:79], v[88:103]
  v_cvt_pk_bf16_f32 v84, v64, v65
  v_exp_f32 v68, v68
  v_exp_f32 v69, v69
  v_cvt_pk_bf16_f32 v85, v66, v67
  v_exp_f32 v70, v70
  v_exp_f32 v71, v71
  v_cvt_pk_bf16_f32 v86, v68, v69
  v_cvt_pk_bf16_f32 v87, v70, v71
  s_waitcnt lgkmcnt(0)
  v_mfma_f32_32x32x16_bf16 v[56:71], v[16:19], v[8:11], 0
  ds_read_b128 v[12:15], v120 offset:4128
  v_exp_f32 v40, v40
  v_exp_f32 v41, v41
  v_exp_f32 v42, v42
  v_exp_f32 v43, v43
  v_cvt_pk_bf16_f32 v72, v40, v41
  v_exp_f32 v44, v44
  v_exp_f32 v45, v45
  v_cvt_pk_bf16_f32 v73, v42, v43
  v_mfma_f32_32x32x16_bf16 v[104:119], v[20:23], v[80:83], v[104:119]
  v_exp_f32 v46, v46
  v_exp_f32 v47, v47
  v_cvt_pk_bf16_f32 v74, v44, v45
  v_exp_f32 v48, v48
  v_exp_f32 v49, v49
  v_cvt_pk_bf16_f32 v75, v46, v47
  v_exp_f32 v50, v50
  v_exp_f32 v51, v51
  v_mfma_f32_32x32x16_bf16 v[104:119], v[24:27], v[84:87], v[104:119]
  ds_read_b128 v[20:23], v122 offset:4128
  ds_read_b128 v[24:27], v123 offset:4128
  v_cvt_pk_bf16_f32 v76, v48, v49
  v_exp_f32 v52, v52
  v_exp_f32 v53, v53
  v_cvt_pk_bf16_f32 v77, v50, v51
  v_exp_f32 v54, v54
  v_exp_f32 v55, v55
  v_cvt_pk_bf16_f32 v78, v52, v53
  v_cvt_pk_bf16_f32 v79, v54, v55
  s_waitcnt lgkmcnt(2)
  v_mfma_f32_32x32x16_bf16 v[40:55], v[12:15], v[4:7], 0
  v_exp_f32 v56, v56
  v_exp_f32 v57, v57
  v_exp_f32 v58, v58
  v_exp_f32 v59, v59
  v_cvt_pk_bf16_f32 v80, v56, v57
  v_exp_f32 v60, v60
  v_exp_f32 v61, v61
  v_cvt_pk_bf16_f32 v81, v58, v59
  v_mfma_f32_32x32x16_bf16 v[88:103], v[28:31], v[72:75], v[88:103]
  v_exp_f32 v62, v62
  v_exp_f32 v63, v63
  v_cvt_pk_bf16_f32 v82, v60, v61
  v_exp_f32 v64, v64
  v_exp_f32 v65, v65
  v_cvt_pk_bf16_f32 v83, v62, v63
  v_exp_f32 v66, v66
  v_exp_f32 v67, v67
  v_mfma_f32_32x32x16_bf16 v[88:103], v[32:35], v[76:79], v[88:103]
  v_cvt_pk_bf16_f32 v84, v64, v65
  v_exp_f32 v68, v68
  v_exp_f32 v69, v69
  v_cvt_pk_bf16_f32 v85, v66, v67
  v_exp_f32 v70, v70
  v_exp_f32 v71, v71
  v_cvt_pk_bf16_f32 v86, v68, v69
  v_cvt_pk_bf16_f32 v87, v70, v71
  s_waitcnt lgkmcnt(0)
  v_mfma_f32_32x32x16_bf16 v[56:71], v[12:15], v[8:11], 0
  ds_read_b128 v[16:19], v120 offset:6192
  v_exp_f32 v40, v40
  v_exp_f32 v41, v41
  v_exp_f32 v42, v42
  v_exp_f32 v43, v43
  v_cvt_pk_bf16_f32 v72, v40, v41
  v_exp_f32 v44, v44
  v_exp_f32 v45, v45
  v_cvt_pk_bf16_f32 v73, v42, v43
  v_mfma_f32_32x32x16_bf16 v[104:119], v[28:31], v[80:83], v[104:119]
  v_exp_f32 v46, v46
  v_exp_f32 v47, v47
  v_cvt_pk_bf16_f32 v74, v44, v45
  v_exp_f32 v48, v48
  v_exp_f32 v49, v49
  v_cvt_pk_bf16_f32 v75, v46, v47
  v_exp_f32 v50, v50
  v_exp_f32 v51, v51
  v_mfma_f32_32x32x16_bf16 v[104:119], v[32:35], v[84:87], v[104:119]
  ds_read_b128 v[28:31], v122 offset:6192
  ds_read_b128 v[32:35], v123 offset:6192
  v_cvt_pk_bf16_f32 v76, v48, v49
  v_exp_f32 v52, v52
  v_exp_f32 v53, v53
  v_cvt_pk_bf16_f32 v77, v50, v51
  v_exp_f32 v54, v54
  v_exp_f32 v55, v55
  v_cvt_pk_bf16_f32 v78, v52, v53
  v_cvt_pk_bf16_f32 v79, v54, v55
  s_waitcnt lgkmcnt(2)
  v_mfma_f32_32x32x16_bf16 v[40:55], v[16:19], v[4:7], 0
  v_exp_f32 v56, v56
  v_exp_f32 v57, v57
  v_exp_f32 v58, v58
  v_exp_f32 v59, v59
  v_cvt_pk_bf16_f32 v80, v56, v57
  v_exp_f32 v60, v60
  v_exp_f32 v61, v61
  v_cvt_pk_bf16_f32 v81, v58, v59
  v_mfma_f32_32x32x16_bf16 v[88:103], v[20:23], v[72:75], v[88:103]
  v_exp_f32 v62, v62
  v_exp_f32 v63, v63
  v_cvt_pk_bf16_f32 v82, v60, v61
  v_exp_f32 v64, v64
  v_exp_f32 v65, v65
  v_cvt_pk_bf16_f32 v83, v62, v63
  v_exp_f32 v66, v66
  v_exp_f32 v67, v67
  v_mfma_f32_32x32x16_bf16 v[88:103], v[24:27], v[76:79], v[88:103]
  v_cvt_pk_bf16_f32 v84, v64, v65
  v_exp_f32 v68, v68
  v_exp_f32 v69, v69
  v_cvt_pk_bf16_f32 v85, v66, v67
  v_exp_f32 v70, v70
  v_exp_f32 v71, v71
  v_cvt_pk_bf16_f32 v86, v68, v69
  v_cvt_pk_bf16_f32 v87, v70, v71
  s_waitcnt lgkmcnt(0)
  v_mfma_f32_32x32x16_bf16 v[56:71], v[16:19], v[8:11], 0
  ds_read_b128 v[12:15], v120 offset:8256
  v_exp_f32 v40, v40
  v_exp_f32 v41, v41
  v_exp_f32 v42, v42
  v_exp_f32 v43, v43
  v_cvt_pk_bf16_f32 v72, v40, v41
  v_exp_f32 v44, v44
  v_exp_f32 v45, v45
  v_cvt_pk_bf16_f32 v73, v42, v43
  v_mfma_f32_32x32x16_bf16 v[104:119], v[20:23], v[80:83], v[104:119]
  v_exp_f32 v46, v46
  v_exp_f32 v47, v47
  v_cvt_pk_bf16_f32 v74, v44, v45
  v_exp_f32 v48, v48
  v_exp_f32 v49, v49
  v_cvt_pk_bf16_f32 v75, v46, v47
  v_exp_f32 v50, v50
  v_exp_f32 v51, v51
  v_mfma_f32_32x32x16_bf16 v[104:119], v[24:27], v[84:87], v[104:119]
  ds_read_b128 v[20:23], v122 offset:8256
  ds_read_b128 v[24:27], v123 offset:8256
  v_cvt_pk_bf16_f32 v76, v48, v49
  v_exp_f32 v52, v52
  v_exp_f32 v53, v53
  v_cvt_pk_bf16_f32 v77, v50, v51
  v_exp_f32 v54, v54
  v_exp_f32 v55, v55
  v_cvt_pk_bf16_f32 v78, v52, v53
  v_cvt_pk_bf16_f32 v79, v54, v55
  s_waitcnt lgkmcnt(2)
  v_mfma_f32_32x32x16_bf16 v[40:55], v[12:15], v[4:7], 0
  v_exp_f32 v56, v56
  v_exp_f32 v57, v57
  v_exp_f32 v58, v58
  v_exp_f32 v59, v59
  v_cvt_pk_bf16_f32 v80, v56, v57
  v_exp_f32 v60, v60
  v_exp_f32 v61, v61
  v_cvt_pk_bf16_f32 v81, v58, v59
  v_mfma_f32_32x32x16_bf16 v[88:103], v[28:31], v[72:75], v[88:103]
  v_exp_f32 v62, v62
  v_exp_f32 v63, v63
  v_cvt_pk_bf16_f32 v82, v60, v61
  v_exp_f32 v64, v64
  v_exp_f32 v65, v65
  v_cvt_pk_bf16_f32 v83, v62, v63
  v_exp_f32 v66, v66
  v_exp_f32 v67, v67
  v_mfma_f32_32x32x16_bf16 v[88:103], v[32:35], v[76:79], v[88:103]
  v_cvt_pk_bf16_f32 v84, v64, v65
  v_exp_f32 v68, v68
  v_exp_f32 v69, v69
  v_cvt_pk_bf16_f32 v85, v66, v67
  v_exp_f32 v70, v70
  v_exp_f32 v71, v71
  v_cvt_pk_bf16_f32 v86, v68, v69
  v_cvt_pk_bf16_f32 v87, v70, v71
  s_waitcnt lgkmcnt(0)
  v_mfma_f32_32x32x16_bf16 v[56:71], v[12:15], v[8:11], 0
  ds_read_b128 v[16:19], v120 offset:10320
  v_exp_f32 v40, v40
  v_exp_f32 v41, v41
  v_exp_f32 v42, v42
  v_exp_f32 v43, v43
  v_cvt_pk_bf16_f32 v72, v40, v41
  v_exp_f32 v44, v44
  v_exp_f32 v45, v45
  v_cvt_pk_bf16_f32 v73, v42, v43
  v_mfma_f32_32x32x16_bf16 v[104:119], v[28:31], v[80:83], v[104:119]
  v_exp_f32 v46, v46
  v_exp_f32 v47, v47
  v_cvt_pk_bf16_f32 v74, v44, v45
  v_exp_f32 v48, v48
  v_exp_f32 v49, v49
  v_cvt_pk_bf16_f32 v75, v46, v47
  v_exp_f32 v50, v50
  v_exp_f32 v51, v51
  v_mfma_f32_32x32x16_bf16 v[104:119], v[32:35], v[84:87], v[104:119]
  ds_read_b128 v[28:31], v122 offset:10320
  ds_read_b128 v[32:35], v123 offset:10320
  v_cvt_pk_bf16_f32 v76, v48, v49
  v_exp_f32 v52, v52
  v_exp_f32 v53, v53
  v_cvt_pk_bf16_f32 v77, v50, v51
  v_exp_f32 v54, v54
  v_exp_f32 v55, v55
  v_cvt_pk_bf16_f32 v78, v52, v53
  v_cvt_pk_bf16_f32 v79, v54, v55
  s_waitcnt lgkmcnt(2)
  v_mfma_f32_32x32x16_bf16 v[40:55], v[16:19], v[4:7], 0
  v_exp_f32 v56, v56
  v_exp_f32 v57, v57
  v_exp_f32 v58, v58
  v_exp_f32 v59, v59
  v_cvt_pk_bf16_f32 v80, v56, v57
  v_exp_f32 v60, v60
  v_exp_f32 v61, v61
  v_cvt_pk_bf16_f32 v81, v58, v59
  v_mfma_f32_32x32x16_bf16 v[88:103], v[20:23], v[72:75], v[88:103]
  v_exp_f32 v62, v62
  v_exp_f32 v63, v63
  v_cvt_pk_bf16_f32 v82, v60, v61
  v_exp_f32 v64, v64
  v_exp_f32 v65, v65
  v_cvt_pk_bf16_f32 v83, v62, v63
  v_exp_f32 v66, v66
  v_exp_f32 v67, v67
  v_mfma_f32_32x32x16_bf16 v[88:103], v[24:27], v[76:79], v[88:103]
  v_cvt_pk_bf16_f32 v84, v64, v65
  v_exp_f32 v68, v68
  v_exp_f32 v69, v69
  v_cvt_pk_bf16_f32 v85, v66, v67
  v_exp_f32 v70, v70
  v_exp_f32 v71, v71
  v_cvt_pk_bf16_f32 v86, v68, v69
  v_cvt_pk_bf16_f32 v87, v70, v71
  s_waitcnt lgkmcnt(0)
  v_mfma_f32_32x32x16_bf16 v[56:71], v[16:19], v[8:11], 0
  ds_read_b128 v[12:15], v120 offset:12384
  v_exp_f32 v40, v40
  v_exp_f32 v41, v41
  v_exp_f32 v42, v42
  v_exp_f32 v43, v43
  v_cvt_pk_bf16_f32 v72, v40, v41
  v_exp_f32 v44, v44
  v_exp_f32 v45, v45
  v_cvt_pk_bf16_f32 v73, v42, v43
  v_mfma_f32_32x32x16_bf16 v[104:119], v[20:23], v[80:83], v[104:119]
  v_exp_f32 v46, v46
  v_exp_f32 v47, v47
  v_cvt_pk_bf16_f32 v74, v44, v45
  v_exp_f32 v48, v48
  v_exp_f32 v49, v49
  v_cvt_pk_bf16_f32 v75, v46, v47
  v_exp_f32 v50, v50
  v_exp_f32 v51, v51
  v_mfma_f32_32x32x16_bf16 v[104:119], v[24:27], v[84:87], v[104:119]
  ds_read_b128 v[20:23], v122 offset:12384
  ds_read_b128 v[24:27], v123 offset:12384
  v_cvt_pk_bf16_f32 v76, v48, v49
  v_exp_f32 v52, v52
  v_exp_f32 v53, v53
  v_cvt_pk_bf16_f32 v77, v50, v51
  v_exp_f32 v54, v54
  v_exp_f32 v55, v55
  v_cvt_pk_bf16_f32 v78, v52, v53
  v_cvt_pk_bf16_f32 v79, v54, v55
  s_waitcnt lgkmcnt(2)
  v_mfma_f32_32x32x16_bf16 v[40:55], v[12:15], v[4:7], 0
  v_exp_f32 v56, v56
  v_exp_f32 v57, v57
  v_exp_f32 v58, v58
  v_exp_f32 v59, v59
  v_cvt_pk_bf16_f32 v80, v56, v57
  v_exp_f32 v60, v60
  v_exp_f32 v61, v61
  v_cvt_pk_bf16_f32 v81, v58, v59
  v_mfma_f32_32x32x16_bf16 v[88:103], v[28:31], v[72:75], v[88:103]
  v_exp_f32 v62, v62
  v_exp_f32 v63, v63
  v_cvt_pk_bf16_f32 v82, v60, v61
  v_exp_f32 v64, v64
  v_exp_f32 v65, v65
  v_cvt_pk_bf16_f32 v83, v62, v63
  v_exp_f32 v66, v66
  v_exp_f32 v67, v67
  v_mfma_f32_32x32x16_bf16 v[88:103], v[32:35], v[76:79], v[88:103]
  v_cvt_pk_bf16_f32 v84, v64, v65
  v_exp_f32 v68, v68
  v_exp_f32 v69, v69
  v_cvt_pk_bf16_f32 v85, v66, v67
  v_exp_f32 v70, v70
  v_exp_f32 v71, v71
  v_cvt_pk_bf16_f32 v86, v68, v69
  v_cvt_pk_bf16_f32 v87, v70, v71
  s_waitcnt lgkmcnt(0)
  v_mfma_f32_32x32x16_bf16 v[56:71], v[12:15], v[8:11], 0
  ds_read_b128 v[16:19], v120 offset:14448
  v_exp_f32 v40, v40
  v_exp_f32 v41, v41
  v_exp_f32 v42, v42
  v_exp_f32 v43, v43
  v_cvt_pk_bf16_f32 v72, v40, v41
  v_exp_f32 v44, v44
  v_exp_f32 v45, v45
  v_cvt_pk_bf16_f32 v73, v42, v43
  v_mfma_f32_32x32x16_bf16 v[104:119], v[28:31], v[80:83], v[104:119]
  v_exp_f32 v46, v46
  v_exp_f32 v47, v47
  v_cvt_pk_bf16_f32 v74, v44, v45
  v_exp_f32 v48, v48
  v_exp_f32 v49, v49
  v_cvt_pk_bf16_f32 v75, v46, v47
  v_exp_f32 v50, v50
  v_exp_f32 v51, v51
  v_mfma_f32_32x32x16_bf16 v[104:119], v[32:35], v[84:87], v[104:119]
  ds_read_b128 v[28:31], v122 offset:14448
  ds_read_b128 v[32:35], v123 offset:14448
  v_cvt_pk_bf16_f32 v76, v48, v49
  v_exp_f32 v52, v52
  v_exp_f32 v53, v53
  v_cvt_pk_bf16_f32 v77, v50, v51
  v_exp_f32 v54, v54
  v_exp_f32 v55, v55
  v_cvt_pk_bf16_f32 v78, v52, v53
  v_cvt_pk_bf16_f32 v79, v54, v55
  s_waitcnt lgkmcnt(2)
  v_mfma_f32_32x32x16_bf16 v[40:55], v[16:19], v[4:7], 0
  v_exp_f32 v56, v56
  v_exp_f32 v57, v57
  v_exp_f32 v58, v58
  v_exp_f32 v59, v59
  v_cvt_pk_bf16_f32 v80, v56, v57
  v_exp_f32 v60, v60
  v_exp_f32 v61, v61
  v_cvt_pk_bf16_f32 v81, v58, v59
  v_mfma_f32_32x32x16_bf16 v[88:103], v[20:23], v[72:75], v[88:103]
  v_exp_f32 v62, v62
  v_exp_f32 v63, v63
  v_cvt_pk_bf16_f32 v82, v60, v61
  v_exp_f32 v64, v64
  v_exp_f32 v65, v65
  v_cvt_pk_bf16_f32 v83, v62, v63
  v_exp_f32 v66, v66
  v_exp_f32 v67, v67
  v_mfma_f32_32x32x16_bf16 v[88:103], v[24:27], v[76:79], v[88:103]
  v_cvt_pk_bf16_f32 v84, v64, v65
  v_exp_f32 v68, v68
  v_exp_f32 v69, v69
  v_cvt_pk_bf16_f32 v85, v66, v67
  v_exp_f32 v70, v70
  v_exp_f32 v71, v71
  v_cvt_pk_bf16_f32 v86, v68, v69
  v_cvt_pk_bf16_f32 v87, v70, v71
  s_waitcnt lgkmcnt(0)
  v_mfma_f32_32x32x16_bf16 v[56:71], v[16:19], v[8:11], 0
  ds_read_b128 v[12:15], v121 offset:0
  v_exp_f32 v40, v40
  v_exp_f32 v41, v41
  v_exp_f32 v42, v42
  v_exp_f32 v43, v43
  v_cvt_pk_bf16_f32 v72, v40, v41
  v_exp_f32 v44, v44
  v_exp_f32 v45, v45
  v_cvt_pk_bf16_f32 v73, v42, v43
  v_mfma_f32_32x32x16_bf16 v[104:119], v[20:23], v[80:83], v[104:119]
  v_exp_f32 v46, v46
  v_exp_f32 v47, v47
  v_cvt_pk_bf16_f32 v74, v44, v45
  v_exp_f32 v48, v48
  v_exp_f32 v49, v49
  v_cvt_pk_bf16_f32 v75, v46, v47
  v_exp_f32 v50, v50
  v_exp_f32 v51, v51
  v_mfma_f32_32x32x16_bf16 v[104:119], v[24:27], v[84:87], v[104:119]
  ds_read_b128 v[20:23], v124 offset:0
  ds_read_b128 v[24:27], v125 offset:0
  v_cvt_pk_bf16_f32 v76, v48, v49
  v_exp_f32 v52, v52
  v_exp_f32 v53, v53
  v_cvt_pk_bf16_f32 v77, v50, v51
  v_exp_f32 v54, v54
  v_exp_f32 v55, v55
  v_cvt_pk_bf16_f32 v78, v52, v53
  v_cvt_pk_bf16_f32 v79, v54, v55
  s_waitcnt lgkmcnt(2)
  v_mfma_f32_32x32x16_bf16 v[40:55], v[12:15], v[4:7], 0
  v_exp_f32 v56, v56
  v_exp_f32 v57, v57
  v_exp_f32 v58, v58
  v_exp_f32 v59, v59
  v_cvt_pk_bf16_f32 v80, v56, v57
  v_exp_f32 v60, v60
  v_exp_f32 v61, v61
  v_cvt_pk_bf16_f32 v81, v58, v59
  v_mfma_f32_32x32x16_bf16 v[88:103], v[28:31], v[72:75], v[88:103]
  v_exp_f32 v62, v62
  v_exp_f32 v63, v63
  v_cvt_pk_bf16_f32 v82, v60, v61
  v_exp_f32 v64, v64
  v_exp_f32 v65, v65
  v_cvt_pk_bf16_f32 v83, v62, v63
  v_exp_f32 v66, v66
  v_exp_f32 v67, v67
  v_mfma_f32_32x32x16_bf16 v[88:103], v[32:35], v[76:79], v[88:103]
  v_cvt_pk_bf16_f32 v84, v64, v65
  v_exp_f32 v68, v68
  v_exp_f32 v69, v69
  v_cvt_pk_bf16_f32 v85, v66, v67
  v_exp_f32 v70, v70
  v_exp_f32 v71, v71
  v_cvt_pk_bf16_f32 v86, v68, v69
  v_cvt_pk_bf16_f32 v87, v70, v71
  v_mov_b32 v120, v121
  v_mov_b32 v122, v124
  v_mov_b32 v123, v125
  s_add_u32 s42, s42, 16512
  s_cmp_eq_u32 s42, s59
  s_cselect_b32 s46, 66048, 0
  s_sub_u32 s42, s42, s46
  v_add_u32 v121, s42, v1
  v_add_u32 v124, s42, v2
  v_add_u32 v125, s42, v3
  s_add_u32 s43, s43, 1
  s_cmp_lt_u32 s43, 3
  s_cbranch_scc1 L_attn_loop
  v_mfma_f32_32x32x16_bf16 v[104:119], v[28:31], v[80:83], v[104:119]
  v_mfma_f32_32x32x16_bf16 v[104:119], v[32:35], v[84:87], v[104:119]
  s_lshr_b32 s47, s3, 2
  v_mov_b32 v36, 156672
  s_mov_b32 s58, 0
L_sp_54:
  ds_read_b128 v[40:43], v36
  s_add_u32 s58, s58, 1
  s_waitcnt lgkmcnt(0)
  v_min3_u32 v40, v40, v41, v42
  v_min_u32 v40, v40, v43
  s_nop 0
  v_readfirstlane_b32 s57, v40
  s_cmp_ge_u32 s58, 0x100000
  s_cbranch_scc1 L_spd_55
  s_cmp_lt_u32 s57, 1
  s_cbranch_scc1 L_sp_54
L_spd_55:
  s_nop 7
  s_cmp_eq_u32 s47, 0
  s_cbranch_scc1 L_at_ns
  v_swap_b32 v88, v104
  v_swap_b32 v89, v105
  v_swap_b32 v90, v106
  v_swap_b32 v91, v107
  v_swap_b32 v92, v108
  v_swap_b32 v93, v109
  v_swap_b32 v94, v110
  v_swap_b32 v95, v111
  v_swap_b32 v96, v112
  v_swap_b32 v4, v8
  v_swap_b32 v5, v9
  v_swap_b32 v6, v10
  v_swap_b32 v7, v11
L_at_ns:
  s_mul_i32 s46, s3, 2304
  s_add_u32 s46, s46, 132096
  v_add_u32 v36, s46, v1
  v_lshlrev_b32 v37, 2, v0
  v_add_u32 v37, s46, v37
  ds_write_b128 v36, v[104:107]
  ds_write_b128 v36, v[108:111] offset:1024
  ds_write_b32 v37, v112 offset:2048
  s_lshl_b32 s48, s3, 2
  s_add_u32 s48, s48, 156688
  v_mov_b32 v38, s48
  v_mov_b32 v39, 1
  s_waitcnt lgkmcnt(0)
  ds_write_b32 v38, v39
  s_xor_b32 s48, s3, 4
  s_lshl_b32 s46, s48, 2
  s_add_u32 s46, s46, 156688
  v_mov_b32 v38, s46
  s_mov_b32 s58, 0
L_sp_56:
  ds_read_b32 v40, v38
  s_add_u32 s58, s58, 1
  s_waitcnt lgkmcnt(0)
  s_nop 0
  v_readfirstlane_b32 s57, v40
  s_cmp_ge_u32 s58, 0x100000
  s_cbranch_scc1 L_spd_57
  s_cmp_lt_u32 s57, 1
  s_cbranch_scc1 L_sp_56
L_spd_57:
  s_mul_i32 s46, s48, 2304
  s_add_u32 s46, s46, 132096
  v_add_u32 v36, s46, v1
  v_lshlrev_b32 v37, 2, v0
  v_add_u32 v37, s46, v37
  ds_read_b128 v[40:43], v36
  ds_read_b128 v[44:47], v36 offset:1024
  ds_read_b32 v48, v37 offset:2048
  s_waitcnt lgkmcnt(0)
  v_add_f32 v88, v88, v40
  v_add_f32 v89, v89, v41
  v_add_f32 v90, v90, v42
  v_add_f32 v91, v91, v43
  v_add_f32 v92, v92, v44
  v_add_f32 v93, v93, v45
  v_add_f32 v94, v94, v46
  v_add_f32 v95, v95, v47
  v_add_f32 v96, v96, v48
  s_nop 1
  v_mov_b32 v37, v96
  s_nop 1
  v_permlane32_swap_b32 v96, v37
  s_nop 1
  v_mul_f32 v36, 0, v88
  v_fma_f32 v36, v89, 0, v36
  v_fma_f32 v36, v90, 0, v36
  v_fma_f32 v36, v91, 0, v36
  v_fma_f32 v36, v92, 0, v36
  v_fma_f32 v36, v93, 0, v36
  v_fma_f32 v36, v94, 0, v36
  v_fma_f32 v36, v95, 0, v36
  s_mov_b32 s46, 0x1f800000
  s_mov_b32 s48, 0x5f800000
  v_cmp_le_f32 s[50:51], s46, v96
  v_cmp_ge_f32 s[52:53], s48, v96
  v_cmp_eq_f32 vcc, 0, v36
  s_nop 1
  s_and_b64 s[50:51], s[50:51], s[52:53]
  s_and_b64 vcc, vcc, s[50:51]
  s_cmp_eq_u64 vcc, -1
  s_cbranch_scc0 L_attn_slow
L_attn_norm:
  s_nop 1
  v_mov_b32 v37, v96
  s_nop 1
  v_permlane32_swap_b32 v96, v37
  s_nop 1
  v_rcp_f32 v36, v96
  s_nop 0
  v_mul_f32 v88, v88, v36
  v_mul_f32 v89, v89, v36
  v_mul_f32 v90, v90, v36
  v_mul_f32 v91, v91, v36
  v_mul_f32 v92, v92, v36
  v_mul_f32 v93, v93, v36
  v_mul_f32 v94, v94, v36
  v_mul_f32 v95, v95, v36
  v_cvt_pk_bf16_f32 v72, v88, v89
  v_cvt_pk_bf16_f32 v73, v90, v91
  v_cvt_pk_bf16_f32 v74, v92, v93
  v_cvt_pk_bf16_f32 v75, v94, v95
  v_cmp_eq_u32 vcc, -1, v72
  v_mov_b32 v36, 0x7fc07fc0
  s_nop 0
  v_cndmask_b32 v72, v72, v36, vcc
  buffer_store_dwordx4 v[72:75], v1, s[28:31], s60 offen sc1
  s_branch L_tail_attn
L_tail_gemm:
  s_cmp_lg_u32 s3, 8
  s_cbranch_scc1 L_tail_g1
  s_lshr_b32 s51, s98, 2
  s_lshl_b32 s51, s51, 8
  s_add_u32 s51, s51, 16785408
  v_lshlrev_b32 v2, 2, v0
  v_cmp_gt_u32 vcc, 32, v0
  s_mov_b32 s58, 0
  s_mov_b64 s[62:63], vcc
L_pf_58:
  buffer_load_dword v3, v2, s[28:31], s51 offen sc1
  s_add_u32 s58, s58, 1
  s_waitcnt vmcnt(0)
  v_cmp_eq_u32 vcc, s40, v3
  s_nop 1
  s_and_b64 vcc, vcc, s[62:63]
  s_cmp_eq_u64 vcc, s[62:63]
  s_cbranch_scc1 L_pfd_59
  s_cmp_ge_u32 s58, 0x4000
  s_cbranch_scc1 L_pfd_59
  s_sleep 2
  s_branch L_pf_58
L_pfd_59:
L_tail_g1:
  v_bfe_u32 v6, v0, 2, 1
  v_lshlrev_b32 v6, 10, v6
  v_lshrrev_b32 v7, 3, v0
  v_lshl_add_u32 v6, v7, 6, v6
  v_and_b32 v7, 3, v0
  v_lshl_add_u32 v6, v7, 4, v6
  s_lshl_b32 s44, s50, 14
  v_add_u32 v6, s44, v6
  v_and_b32 v9, 31, v0
  v_mul_u32_u24 v9, 272, v9
  v_lshrrev_b32 v10, 5, v0
  v_lshl_add_u32 v9, v10, 4, v9
  s_mul_i32 s44, s50, 17408
  s_add_u32 s44, s44, 69632
  v_add_u32 v9, s44, v9
  s_waitcnt vmcnt(0)
  s_barrier
  ds_write_b128 v6, v[16:19] offset:0
  ds_write_b128 v6, v[20:23] offset:512
  ds_write_b128 v6, v[24:27] offset:2048
  ds_write_b128 v6, v[28:31] offset:2560
  ds_write_b128 v6, v[32:35] offset:4096
  ds_write_b128 v6, v[36:39] offset:4608
  ds_write_b128 v6, v[40:43] offset:6144
  ds_write_b128 v6, v[44:47] offset:6656
  ds_write_b128 v6, v[128:131] offset:8192
  ds_write_b128 v6, v[132:135] offset:8704
  ds_write_b128 v6, v[136:139] offset:10240
  ds_write_b128 v6, v[140:143] offset:10752
  ds_write_b128 v6, v[144:147] offset:12288
  ds_write_b128 v6, v[148:151] offset:12800
  ds_write_b128 v6, v[152:155] offset:14336
  ds_write_b128 v6, v[156:159] offset:14848
  s_lshl_b32 s46, s50, 2
  s_add_u32 s46, s46, 156720
  v_mov_b32 v2, s46
  v_mov_b32 v3, 1
  s_waitcnt lgkmcnt(0)
  ds_write_b32 v2, v3
  ds_write_b128 v9, v[64:67] offset:0
  ds_write_b128 v9, v[68:71] offset:32
  ds_write_b128 v9, v[72:75] offset:64
  ds_write_b128 v9, v[76:79] offset:96
  ds_write_b128 v9, v[80:83] offset:128
  ds_write_b128 v9, v[84:87] offset:160
  ds_write_b128 v9, v[88:91] offset:192
  ds_write_b128 v9, v[92:95] offset:224
  ds_write_b128 v9, v[96:99] offset:8704
  ds_write_b128 v9, v[100:103] offset:8736
  ds_write_b128 v9, v[104:107] offset:8768
  ds_write_b128 v9, v[108:111] offset:8800
  ds_write_b128 v9, v[112:115] offset:8832
  ds_write_b128 v9, v[116:119] offset:8864
  ds_write_b128 v9, v[120:123] offset:8896
  ds_write_b128 v9, v[124:127] offset:8928
  s_waitcnt lgkmcnt(0)
  s_barrier
  s_barrier
  s_branch L_fin
L_tail_attn:
  s_and_b32 s44, s3, 1
  s_lshr_b32 s45, s3, 1
  s_lshl_b32 s52, s98, 1
  s_add_u32 s52, s52, s44
  s_lshl_b32 s52, s52, 15
  s_lshl_b32 s48, s45, 13
  s_add_u32 s52, s52, s48
  s_add_u32 s52, s52, 14680064
  s_add_u32 s53, s52, 4096
  v_mov_b32 v8, v127
  s_barrier
  buffer_load_dwordx4 v[96:99], v1, s[28:31], s52 offen offset:0 sc1
  buffer_load_dwordx4 v[100:103], v1, s[28:31], s52 offen offset:1024 sc1
  buffer_load_dwordx4 v[104:107], v1, s[28:31], s52 offen offset:2048 sc1
  buffer_load_dwordx4 v[108:111], v1, s[28:31], s52 offen offset:3072 sc1
  buffer_load_dwordx4 v[112:115], v1, s[28:31], s53 offen offset:0 sc1
  buffer_load_dwordx4 v[116:119], v1, s[28:31], s53 offen offset:1024 sc1
  buffer_load_dwordx4 v[120:123], v1, s[28:31], s53 offen offset:2048 sc1
  buffer_load_dwordx4 v[124:127], v1, s[28:31], s53 offen offset:3072 sc1
  v_lshrrev_b32 v5, 3, v0
  s_lshl_b32 s46, s3, 3
  v_add_u32 v5, s46, v5
  v_and_b32 v6, 7, v0
  v_mul_u32_u24 v10, 272, v5
  v_lshl_add_u32 v10, v6, 5, v10
  v_add_u32 v11, 69632, v10
  v_lshrrev_b32 v6, 5, v0
  v_bfe_u32 v7, v0, 2, 2
  v_lshl_add_u32 v7, v6, 2, v7
  v_lshlrev_b32 v7, 6, v7
  v_bfe_u32 v9, v0, 4, 1
  v_lshl_add_u32 v7, v9, 5, v7
  v_and_b32 v9, 3, v0
  v_lshl_add_u32 v7, v9, 3, v7
  s_lshl_b32 s48, s45, 14
  v_add_u32 v7, s48, v7
  v_and_b32 v9, 31, v0
  v_mul_u32_u24 v9, 272, v9
  v_lshl_add_u32 v9, v6, 4, v9
  s_mul_i32 s48, s45, 17408
  s_mul_i32 s49, s44, 8704
  s_add_u32 s48, s48, s49
  v_add_u32 v9, s48, v9
  v_mov_b32 v64, 0
  v_mov_b32 v65, 0
  v_mov_b32 v66, 0
  v_mov_b32 v67, 0
  v_mov_b32 v68, 0
  v_mov_b32 v69, 0
  v_mov_b32 v70, 0
  v_mov_b32 v71, 0
  v_mov_b32 v72, 0
  v_mov_b32 v73, 0
  v_mov_b32 v74, 0
  v_mov_b32 v75, 0
  v_mov_b32 v76, 0
  v_mov_b32 v77, 0
  v_mov_b32 v78, 0
  v_mov_b32 v79, 0
  v_mov_b32 v80, 0
  v_mov_b32 v81, 0
  v_mov_b32 v82, 0
  v_mov_b32 v83, 0
  v_mov_b32 v84, 0
  v_mov_b32 v85, 0
  v_mov_b32 v86, 0
  v_mov_b32 v87, 0
  v_mov_b32 v88, 0
  v_mov_b32 v89, 0
  v_mov_b32 v90, 0
  v_mov_b32 v91, 0
  v_mov_b32 v92, 0
  v_mov_b32 v93, 0
  v_mov_b32 v94, 0
  v_mov_b32 v95, 0
  v_mov_b32 v12, 156720
  s_mov_b32 s58, 0
L_sp_60:
  ds_read_b128 v[16:19], v12
  s_add_u32 s58, s58, 1
  s_waitcnt lgkmcnt(0)
  v_min3_u32 v16, v16, v17, v18
  v_min_u32 v16, v16, v19
  s_nop 0
  v_readfirstlane_b32 s57, v16
  s_cmp_ge_u32 s58, 0x100000
  s_cbranch_scc1 L_spd_61
  s_cmp_lt_u32 s57, 1
  s_cbranch_scc1 L_sp_60
L_spd_61:
  ds_read_b64_tr_b16 v[128:129], v7 offset:0
  ds_read_b64_tr_b16 v[130:131], v7 offset:512
  ds_read_b64_tr_b16 v[132:133], v7 offset:1024
  ds_read_b64_tr_b16 v[134:135], v7 offset:1536
  ds_read_b64_tr_b16 v[136:137], v7 offset:2048
  ds_read_b64_tr_b16 v[138:139], v7 offset:2560
  ds_read_b64_tr_b16 v[140:141], v7 offset:3072
  ds_read_b64_tr_b16 v[142:143], v7 offset:3584
  ds_read_b64_tr_b16 v[144:145], v7 offset:4096
  ds_read_b64_tr_b16 v[146:147], v7 offset:4608
  ds_read_b64_tr_b16 v[148:149], v7 offset:5120
  ds_read_b64_tr_b16 v[150:151], v7 offset:5632
  s_waitcnt lgkmcnt(0)
  ds_read_b64_tr_b16 v[152:153], v7 offset:6144
  ds_read_b64_tr_b16 v[154:155], v7 offset:6656
  ds_read_b64_tr_b16 v[156:157], v7 offset:7168
  ds_read_b64_tr_b16 v[158:159], v7 offset:7680
  ds_read_b64_tr_b16 v[32:33], v7 offset:8192
  ds_read_b64_tr_b16 v[34:35], v7 offset:8704
  ds_read_b64_tr_b16 v[36:37], v7 offset:9216
  ds_read_b64_tr_b16 v[38:39], v7 offset:9728
  ds_read_b64_tr_b16 v[40:41], v7 offset:10240
  ds_read_b64_tr_b16 v[42:43], v7 offset:10752
  ds_read_b64_tr_b16 v[44:45], v7 offset:11264
  ds_read_b64_tr_b16 v[46:47], v7 offset:11776
  s_waitcnt lgkmcnt(0)
  ds_read_b64_tr_b16 v[48:49], v7 offset:12288
  ds_read_b64_tr_b16 v[50:51], v7 offset:12800
  ds_read_b64_tr_b16 v[52:53], v7 offset:13312
  ds_read_b64_tr_b16 v[54:55], v7 offset:13824
  ds_read_b64_tr_b16 v[56:57], v7 offset:14336
  ds_read_b64_tr_b16 v[58:59], v7 offset:14848
  ds_read_b64_tr_b16 v[60:61], v7 offset:15360
  ds_read_b64_tr_b16 v[62:63], v7 offset:15872
  s_waitcnt lgkmcnt(0)
  s_mov_b32 s58, 0
  s_mov_b32 s55, 0xff
  s_waitcnt vmcnt(0)
  s_bitcmp1_b32 s55, 0
  s_cbranch_scc0 L_on_66
  v_cmp_eq_u32 vcc, -1, v96
  s_nop 1
  s_cmp_eq_u64 vcc, 0
  s_cbranch_scc0 L_or_67
  v_mfma_f32_32x32x16_bf16 v[64:79], v[128:131], v[96:99], v[64:79]
  v_mfma_f32_32x32x16_bf16 v[80:95], v[132:135], v[96:99], v[80:95]
  s_bitset0_b32 s55, 0
  s_branch L_on_66
L_or_67:
  buffer_load_dwordx4 v[96:99], v1, s[28:31], s52 offen offset:0 sc1
L_on_66:
  s_bitcmp1_b32 s55, 1
  s_cbranch_scc0 L_on_68
  v_cmp_eq_u32 vcc, -1, v100
  s_nop 1
  s_cmp_eq_u64 vcc, 0
  s_cbranch_scc0 L_or_69
  v_mfma_f32_32x32x16_bf16 v[64:79], v[136:139], v[100:103], v[64:79]
  v_mfma_f32_32x32x16_bf16 v[80:95], v[140:143], v[100:103], v[80:95]
  s_bitset0_b32 s55, 1
  s_branch L_on_68
L_or_69:
  buffer_load_dwordx4 v[100:103], v1, s[28:31], s52 offen offset:1024 sc1
L_on_68:
  s_bitcmp1_b32 s55, 2
  s_cbranch_scc0 L_on_70
  v_cmp_eq_u32 vcc, -1, v104
  s_nop 1
  s_cmp_eq_u64 vcc, 0
  s_cbranch_scc0 L_or_71
  v_mfma_f32_32x32x16_bf16 v[64:79], v[144:147], v[104:107], v[64:79]
  v_mfma_f32_32x32x16_bf16 v[80:95], v[148:151], v[104:107], v[80:95]
  s_bitset0_b32 s55, 2
  s_branch L_on_70
L_or_71:
  buffer_load_dwordx4 v[104:107], v1, s[28:31], s52 offen offset:2048 sc1
L_on_70:
  s_bitcmp1_b32 s55, 3
  s_cbranch_scc0 L_on_72
  v_cmp_eq_u32 vcc, -1, v108
  s_nop 1
  s_cmp_eq_u64 vcc, 0
  s_cbranch_scc0 L_or_73
  v_mfma_f32_32x32x16_bf16 v[64:79], v[152:155], v[108:111], v[64:79]
  v_mfma_f32_32x32x16_bf16 v[80:95], v[156:159], v[108:111], v[80:95]
  s_bitset0_b32 s55, 3
  s_branch L_on_72
L_or_73:
  buffer_load_dwordx4 v[108:111], v1, s[28:31], s52 offen offset:3072 sc1
L_on_72:
  s_bitcmp1_b32 s55, 4
  s_cbranch_scc0 L_on_74
  v_cmp_eq_u32 vcc, -1, v112
  s_nop 1
  s_cmp_eq_u64 vcc, 0
  s_cbranch_scc0 L_or_75
  v_mfma_f32_32x32x16_bf16 v[64:79], v[32:35], v[112:115], v[64:79]
  v_mfma_f32_32x32x16_bf16 v[80:95], v[36:39], v[112:115], v[80:95]
  s_bitset0_b32 s55, 4
  s_branch L_on_74
L_or_75:
  buffer_load_dwordx4 v[112:115], v1, s[28:31], s53 offen offset:0 sc1
L_on_74:
  s_bitcmp1_b32 s55, 5
  s_cbranch_scc0 L_on_76
  v_cmp_eq_u32 vcc, -1, v116
  s_nop 1
  s_cmp_eq_u64 vcc, 0
  s_cbranch_scc0 L_or_77
  v_mfma_f32_32x32x16_bf16 v[64:79], v[40:43], v[116:119], v[64:79]
  v_mfma_f32_32x32x16_bf16 v[80:95], v[44:47], v[116:119], v[80:95]
  s_bitset0_b32 s55, 5
  s_branch L_on_76
L_or_77:
  buffer_load_dwordx4 v[116:119], v1, s[28:31], s53 offen offset:1024 sc1
L_on_76:
  s_bitcmp1_b32 s55, 6
  s_cbranch_scc0 L_on_78
  v_cmp_eq_u32 vcc, -1, v120
  s_nop 1
  s_cmp_eq_u64 vcc, 0
  s_cbranch_scc0 L_or_79
  v_mfma_f32_32x32x16_bf16 v[64:79], v[48:51], v[120:123], v[64:79]
  v_mfma_f32_32x32x16_bf16 v[80:95], v[52:55], v[120:123], v[80:95]
  s_bitset0_b32 s55, 6
  s_branch L_on_78
L_or_79:
  buffer_load_dwordx4 v[120:123], v1, s[28:31], s53 offen offset:2048 sc1
L_on_78:
  s_bitcmp1_b32 s55, 7
  s_cbranch_scc0 L_on_80
  v_cmp_eq_u32 vcc, -1, v124
  s_nop 1
  s_cmp_eq_u64 vcc, 0
  s_cbranch_scc0 L_or_81
  v_mfma_f32_32x32x16_bf16 v[64:79], v[56:59], v[124:127], v[64:79]
  v_mfma_f32_32x32x16_bf16 v[80:95], v[60:63], v[124:127], v[80:95]
  s_bitset0_b32 s55, 7
  s_branch L_on_80
L_or_81:
  buffer_load_dwordx4 v[124:127], v1, s[28:31], s53 offen offset:3072 sc1
L_on_80:
L_p1_65:
  s_barrier
  ds_read_b128 v[12:15], v11 offset:0
  ds_read_b128 v[16:19], v11 offset:17408
  s_waitcnt lgkmcnt(0)
  v_add_f32 v20, v12, v16
  v_add_f32 v21, v13, v17
  v_add_f32 v22, v14, v18
  v_add_f32 v23, v15, v19
  ds_read_b128 v[12:15], v11 offset:34816
  ds_read_b128 v[16:19], v11 offset:52224
  s_waitcnt lgkmcnt(0)
  v_add_f32 v12, v12, v16
  v_add_f32 v20, v20, v12
  v_add_f32 v13, v13, v17
  v_add_f32 v21, v21, v13
  v_add_f32 v14, v14, v18
  v_add_f32 v22, v22, v14
  v_add_f32 v15, v15, v19
  v_add_f32 v23, v23, v15
  ds_read_b128 v[12:15], v11 offset:16
  ds_read_b128 v[16:19], v11 offset:17424
  s_waitcnt lgkmcnt(0)
  v_add_f32 v24, v12, v16
  v_add_f32 v25, v13, v17
  v_add_f32 v26, v14, v18
  v_add_f32 v27, v15, v19
  ds_read_b128 v[12:15], v11 offset:34832
  ds_read_b128 v[16:19], v11 offset:52240
  s_waitcnt lgkmcnt(0)
  v_add_f32 v12, v12, v16
  v_add_f32 v24, v24, v12
  v_add_f32 v13, v13, v17
  v_add_f32 v25, v25, v13
  v_add_f32 v14, v14, v18
  v_add_f32 v26, v26, v14
  v_add_f32 v15, v15, v19
  v_add_f32 v27, v27, v15
  v_lshlrev_b32 v28, 16, v164
  v_and_b32 v29, 0xffff0000, v164
  v_add_f32 v20, v20, v28
  v_add_f32 v21, v21, v29
  v_lshlrev_b32 v28, 16, v165
  v_and_b32 v29, 0xffff0000, v165
  v_add_f32 v22, v22, v28
  v_add_f32 v23, v23, v29
  v_lshlrev_b32 v28, 16, v166
  v_and_b32 v29, 0xffff0000, v166
  v_add_f32 v24, v24, v28
  v_add_f32 v25, v25, v29
  v_lshlrev_b32 v28, 16, v167
  v_and_b32 v29, 0xffff0000, v167
  v_add_f32 v26, v26, v28
  v_add_f32 v27, v27, v29
L_ochk_62:
  s_cmp_eq_u32 s55, 0
  s_cbranch_scc1 L_ook_63
  s_add_u32 s58, s58, 1
  s_cmp_ge_u32 s58, 0x4000
  s_cbranch_scc1 L_ook_63
  s_waitcnt vmcnt(0)
  s_bitcmp1_b32 s55, 0
  s_cbranch_scc0 L_on_82
  v_cmp_eq_u32 vcc, -1, v96
  s_nop 1
  s_cmp_eq_u64 vcc, 0
  s_cbranch_scc0 L_or_83
  v_mfma_f32_32x32x16_bf16 v[64:79], v[128:131], v[96:99], v[64:79]
  v_mfma_f32_32x32x16_bf16 v[80:95], v[132:135], v[96:99], v[80:95]
  s_bitset0_b32 s55, 0
  s_branch L_on_82
L_or_83:
  buffer_load_dwordx4 v[96:99], v1, s[28:31], s52 offen offset:0 sc1
L_on_82:
  s_bitcmp1_b32 s55, 1
  s_cbranch_scc0 L_on_84
  v_cmp_eq_u32 vcc, -1, v100
  s_nop 1
  s_cmp_eq_u64 vcc, 0
  s_cbranch_scc0 L_or_85
  v_mfma_f32_32x32x16_bf16 v[64:79], v[136:139], v[100:103], v[64:79]
  v_mfma_f32_32x32x16_bf16 v[80:95], v[140:143], v[100:103], v[80:95]
  s_bitset0_b32 s55, 1
  s_branch L_on_84
L_or_85:
  buffer_load_dwordx4 v[100:103], v1, s[28:31], s52 offen offset:1024 sc1
L_on_84:
  s_bitcmp1_b32 s55, 2
  s_cbranch_scc0 L_on_86
  v_cmp_eq_u32 vcc, -1, v104
  s_nop 1
  s_cmp_eq_u64 vcc, 0
  s_cbranch_scc0 L_or_87
  v_mfma_f32_32x32x16_bf16 v[64:79], v[144:147], v[104:107], v[64:79]
  v_mfma_f32_32x32x16_bf16 v[80:95], v[148:151], v[104:107], v[80:95]
  s_bitset0_b32 s55, 2
  s_branch L_on_86
L_or_87:
  buffer_load_dwordx4 v[104:107], v1, s[28:31], s52 offen offset:2048 sc1
L_on_86:
  s_bitcmp1_b32 s55, 3
  s_cbranch_scc0 L_on_88
  v_cmp_eq_u32 vcc, -1, v108
  s_nop 1
  s_cmp_eq_u64 vcc, 0
  s_cbranch_scc0 L_or_89
  v_mfma_f32_32x32x16_bf16 v[64:79], v[152:155], v[108:111], v[64:79]
  v_mfma_f32_32x32x16_bf16 v[80:95], v[156:159], v[108:111], v[80:95]
  s_bitset0_b32 s55, 3
  s_branch L_on_88
L_or_89:
  buffer_load_dwordx4 v[108:111], v1, s[28:31], s52 offen offset:3072 sc1
L_on_88:
  s_bitcmp1_b32 s55, 4
  s_cbranch_scc0 L_on_90
  v_cmp_eq_u32 vcc, -1, v112
  s_nop 1
  s_cmp_eq_u64 vcc, 0
  s_cbranch_scc0 L_or_91
  v_mfma_f32_32x32x16_bf16 v[64:79], v[32:35], v[112:115], v[64:79]
  v_mfma_f32_32x32x16_bf16 v[80:95], v[36:39], v[112:115], v[80:95]
  s_bitset0_b32 s55, 4
  s_branch L_on_90
L_or_91:
  buffer_load_dwordx4 v[112:115], v1, s[28:31], s53 offen offset:0 sc1
L_on_90:
  s_bitcmp1_b32 s55, 5
  s_cbranch_scc0 L_on_92
  v_cmp_eq_u32 vcc, -1, v116
  s_nop 1
  s_cmp_eq_u64 vcc, 0
  s_cbranch_scc0 L_or_93
  v_mfma_f32_32x32x16_bf16 v[64:79], v[40:43], v[116:119], v[64:79]
  v_mfma_f32_32x32x16_bf16 v[80:95], v[44:47], v[116:119], v[80:95]
  s_bitset0_b32 s55, 5
  s_branch L_on_92
L_or_93:
  buffer_load_dwordx4 v[116:119], v1, s[28:31], s53 offen offset:1024 sc1
L_on_92:
  s_bitcmp1_b32 s55, 6
  s_cbranch_scc0 L_on_94
  v_cmp_eq_u32 vcc, -1, v120
  s_nop 1
  s_cmp_eq_u64 vcc, 0
  s_cbranch_scc0 L_or_95
  v_mfma_f32_32x32x16_bf16 v[64:79], v[48:51], v[120:123], v[64:79]
  v_mfma_f32_32x32x16_bf16 v[80:95], v[52:55], v[120:123], v[80:95]
  s_bitset0_b32 s55, 6
  s_branch L_on_94
L_or_95:
  buffer_load_dwordx4 v[120:123], v1, s[28:31], s53 offen offset:2048 sc1
L_on_94:
  s_bitcmp1_b32 s55, 7
  s_cbranch_scc0 L_on_96
  v_cmp_eq_u32 vcc, -1, v124
  s_nop 1
  s_cmp_eq_u64 vcc, 0
  s_cbranch_scc0 L_or_97
  v_mfma_f32_32x32x16_bf16 v[64:79], v[56:59], v[124:127], v[64:79]
  v_mfma_f32_32x32x16_bf16 v[80:95], v[60:63], v[124:127], v[80:95]
  s_bitset0_b32 s55, 7
  s_branch L_on_96
L_or_97:
  buffer_load_dwordx4 v[124:127], v1, s[28:31], s53 offen offset:3072 sc1
L_on_96:
  s_branch L_ochk_62
L_ook_63:
  v_mul_f32 v12, 0xbfb8aa3b, v20
  v_mul_f32 v13, 0xbfb8aa3b, v21
  v_mul_f32 v14, 0xbfb8aa3b, v22
  v_mul_f32 v15, 0xbfb8aa3b, v23
  v_mul_f32 v16, 0xbfb8aa3b, v24
  v_mul_f32 v17, 0xbfb8aa3b, v25
  v_mul_f32 v18, 0xbfb8aa3b, v26
  v_mul_f32 v19, 0xbfb8aa3b, v27
  v_exp_f32 v12, v12
  v_exp_f32 v13, v13
  v_exp_f32 v14, v14
  v_exp_f32 v15, v15
  v_exp_f32 v16, v16
  v_exp_f32 v17, v17
  v_exp_f32 v18, v18
  v_exp_f32 v19, v19
  ds_write_b128 v9, v[64:67] offset:0
  ds_write_b128 v9, v[68:71] offset:32
  ds_write_b128 v9, v[72:75] offset:64
  ds_write_b128 v9, v[76:79] offset:96
  ds_write_b128 v9, v[80:83] offset:128
  ds_write_b128 v9, v[84:87] offset:160
  ds_write_b128 v9, v[88:91] offset:192
  ds_write_b128 v9, v[92:95] offset:224
  v_add_f32 v12, 1.0, v12
  v_add_f32 v13, 1.0, v13
  v_add_f32 v14, 1.0, v14
  v_add_f32 v15, 1.0, v15
  v_add_f32 v16, 1.0, v16
  v_add_f32 v17, 1.0, v17
  v_add_f32 v18, 1.0, v18
  v_add_f32 v19, 1.0, v19
  v_rcp_f32 v12, v12
  v_rcp_f32 v13, v13
  v_rcp_f32 v14, v14
  v_rcp_f32 v15, v15
  v_rcp_f32 v16, v16
  v_rcp_f32 v17, v17
  v_rcp_f32 v18, v18
  v_rcp_f32 v19, v19
  s_mov_b32 s36, s20
  s_and_b32 s37, s21, 0xffff
  s_mov_b32 s38, 2097152
  s_mov_b32 s39, 0x20000
  v_mul_f32 v20, v20, v12
  v_mul_f32 v21, v21, v13
  v_mul_f32 v22, v22, v14
  v_mul_f32 v23, v23, v15
  v_mul_f32 v24, v24, v16
  v_mul_f32 v25, v25, v17
  v_mul_f32 v26, v26, v18
  v_mul_f32 v27, v27, v19
  s_waitcnt lgkmcnt(0)
  s_barrier
  ds_read_b128 v[32:35], v10 offset:0
  ds_read_b128 v[36:39], v10 offset:16
  ds_read_b128 v[40:43], v10 offset:17408
  ds_read_b128 v[44:47], v10 offset:17424
  ds_read_b128 v[48:51], v10 offset:34816
  ds_read_b128 v[52:55], v10 offset:34832
  ds_read_b128 v[56:59], v10 offset:52224
  ds_read_b128 v[60:63], v10 offset:52240
  s_waitcnt lgkmcnt(0)
  v_add_f32 v32, v32, v40
  v_add_f32 v48, v48, v56
  v_add_f32 v33, v33, v41
  v_add_f32 v49, v49, v57
  v_add_f32 v34, v34, v42
  v_add_f32 v50, v50, v58
  v_add_f32 v35, v35, v43
  v_add_f32 v51, v51, v59
  v_add_f32 v36, v36, v44
  v_add_f32 v52, v52, v60
  v_add_f32 v37, v37, v45
  v_add_f32 v53, v53, v61
  v_add_f32 v38, v38, v46
  v_add_f32 v54, v54, v62
  v_add_f32 v39, v39, v47
  v_add_f32 v55, v55, v63
  v_add_f32 v96, v32, v48
  v_add_f32 v97, v33, v49
  v_add_f32 v98, v34, v50
  v_add_f32 v99, v35, v51
  v_add_f32 v100, v36, v52
  v_add_f32 v101, v37, v53
  v_add_f32 v102, v38, v54
  v_add_f32 v103, v39, v55
  v_lshlrev_b32 v28, 16, v160
  v_and_b32 v29, 0xffff0000, v160
  v_fma_f32 v96, v96, v20, v28
  v_fma_f32 v97, v97, v21, v29
  v_lshlrev_b32 v28, 16, v161
  v_and_b32 v29, 0xffff0000, v161
  v_fma_f32 v98, v98, v22, v28
  v_fma_f32 v99, v99, v23, v29
  v_lshlrev_b32 v28, 16, v162
  v_and_b32 v29, 0xffff0000, v162
  v_fma_f32 v100, v100, v24, v28
  v_fma_f32 v101, v101, v25, v29
  v_lshlrev_b32 v28, 16, v163
  v_and_b32 v29, 0xffff0000, v163
  v_fma_f32 v102, v102, v26, v28
  v_fma_f32 v103, v103, v27, v29
  v_cvt_pk_bf16_f32 v104, v96, v97
  v_cvt_pk_bf16_f32 v105, v98, v99
  v_cvt_pk_bf16_f32 v106, v100, v101
  v_cvt_pk_bf16_f32 v107, v102, v103
  buffer_store_dwordx4 v[104:107], v8, s[36:39], s61 offen sc1
L_fin:
L_end:
  s_endpgm
L_code_end:
.fill 256, 4, 0xbf800000
.section .rodata,"a"
.p2align 6
.amdhsa_kernel recurrent_scan__mha_block__dense_activation_squared_relu__prompt_kernel
  .amdhsa_next_free_vgpr 168
  .amdhsa_next_free_sgpr 102
  .amdhsa_accum_offset 168
  .amdhsa_group_segment_fixed_size 0
  .amdhsa_kernarg_size 88
  .amdhsa_user_sgpr_count 2
  .amdhsa_user_sgpr_kernarg_segment_ptr 1
  .amdhsa_system_sgpr_workgroup_id_x 1
.end_amdhsa_kernel
```
